```python
import torch

def _softmax(x, axis=-1):
    return torch.softmax(x, dim=axis)
def _gelu(x):
    return torch.nn.functional.gelu(x, approximate="tanh")
def _silu(x):
    return torch.nn.functional.silu(x)
def _sigmoid(x):
    return torch.sigmoid(x)
def _layernorm(x, axis=-1, eps=1e-5):
    m = x.mean(dim=axis, keepdim=True)
    v = x.var(dim=axis, keepdim=True, unbiased=False)
    return (x - m) / torch.sqrt(v + eps)
def _scatter_add(tgt, idx, src, axis=0):
    return tgt.clone().index_add_(axis, idx, src)
def _segment_sum(src, seg, n):
    out = torch.zeros((n,) + src.shape[1:], dtype=src.dtype)
    return out.index_add_(0, seg, src)
def _pad(x, pw):
    flat = tuple(v for pair in reversed(pw) for v in pair)
    return torch.nn.functional.pad(x, flat)

kernel_name = 'standalone__gqa_softmax__near_ridge'

def setup_inputs():

    _w = (lambda a: (lambda t: t.to(torch.bfloat16) if t.is_floating_point() else t)(torch.as_tensor(a)))
    B, Hq, Hkv, Sq, Sk, D = 32, 32, 4, 256, 256, 128
    return {
        "q": _w((lambda *s: torch.randn(*s, dtype=torch.bfloat16) * 0.8)(B, Hq, Sq, D)),
        "k": _w((lambda *s: torch.randn(*s, dtype=torch.bfloat16) * 0.8)(B, Hkv, Sk, D)),
        "v": _w((lambda *s: torch.randn(*s, dtype=torch.bfloat16) * 0.05)(B, Hkv, Sk, D)),
    }

def reference(q, k, v):
    B, Hq, Sq, D = q.shape
    Hkv = k.shape[1]
    rep = Hq // Hkv
    k = (lambda x, n, axis: torch.repeat_interleave(x, n, dim=axis))(k, rep, axis=1)
    v = (lambda x, n, axis: torch.repeat_interleave(x, n, dim=axis))(v, rep, axis=1)
    scale = D ** -0.5
    scores = torch.einsum("bhqd,bhkd->bhqk", q, k) * scale
    p = _softmax(scores, axis=-1)
    return torch.einsum("bhqk,bhkd->bhqd", p, v)
```

```asm
; @launch grid=(256,1,1) block=(512,1,1) lds=163840
.amdgcn_target "amdgcn-amd-amdhsa--gfx950"
.text
.globl standalone__gqa_softmax__near_ridge_kernel
.p2align 8
.type standalone__gqa_softmax__near_ridge_kernel,@function
standalone__gqa_softmax__near_ridge_kernel:
    s_cmp_ge_u32 s2, 256
    s_cbranch_scc1 L_end
    s_load_dwordx4 s[4:7], s[0:1], 0
    s_load_dwordx4 s[24:27], s[0:1], 16
    s_getpc_b64 s[38:39]
L_pc:
    v_lshlrev_b32 v162, 5, v0
    v_min_u32 v162, L_slow-L_pc-32, v162
    global_load_dwordx4 v[168:171], v162, s[38:39]
    v_lshrrev_b32 v160, 6, v0
    v_and_b32 v166, 63, v0
    v_readfirstlane_b32 s34, v160
    s_lshr_b32 s40, s2, 4
    s_lshl_b32 s40, s40, 3
    s_and_b32 s41, s2, 7
    s_add_u32 s40, s40, s41
    s_bfe_u32 s41, s2, 0x10003
    s_lshl_b32 s37, s40, 16
    s_lshl1_add_u32 s40, s40, s41
    s_lshl_b32 s36, s40, 18
    s_and_b32 s40, s34, 3
    s_lshl_b32 s41, s40, 13
    s_add_u32 s36, s36, s41
    v_lshrrev_b32 v160, 3, v166
    v_and_b32 v161, 7, v166
    v_lshlrev_b32 v113, 10, v160
    v_lshl_add_u32 v113, v161, 4, v113
    v_lshrrev_b32 v163, 4, v166
    s_lshl_b32 s42, s40, 11
    v_lshlrev_b32 v124, 8, v161
    v_lshl_add_u32 v124, v160, 4, v124
    v_add_u32 v124, s42, v124
    s_lshl_b32 s41, s40, 10
    s_lshl_b32 s45, s40, 11
    s_add_u32 s44, s37, s45
    s_add_u32 s45, s45, 0x10000
    v_lshlrev_b32 v125, 4, v166
    s_cmp_lt_u32 s34, 4
    s_waitcnt lgkmcnt(0)
    s_cbranch_scc1 L_groupA
    s_mov_b32 s12, s6
    s_and_b32 s13, s7, 0xffff
    s_mov_b32 s14, 0x800000
    s_mov_b32 s15, 0x20000
    s_mov_b32 s43, s41
    s_add_u32 m0, s41, 0
    s_add_u32 s42, s37, 0
    buffer_load_dwordx4 v124, s[12:15], s42 offen lds
    s_add_u32 m0, s41, 0x1000
    s_add_u32 s42, s37, 0x80
    buffer_load_dwordx4 v124, s[12:15], s42 offen lds
    s_add_u32 m0, s41, 0x2000
    s_add_u32 s42, s37, 0x2000
    buffer_load_dwordx4 v124, s[12:15], s42 offen lds
    s_add_u32 m0, s41, 0x3000
    s_add_u32 s42, s37, 0x2080
    buffer_load_dwordx4 v124, s[12:15], s42 offen lds
    s_branch L_groupB
L_groupA:
    s_mov_b32 s8, s4
    s_and_b32 s9, s5, 0xffff
    s_mov_b32 s10, 0x4000000
    s_mov_b32 s11, 0x20000
    v_xor_b32 v162, v161, v163
    v_lshlrev_b32 v8, 8, v160
    v_lshl_add_u32 v8, v162, 4, v8
    v_xor_b32 v9, 64, v8
    s_lshl_b32 s47, s34, 12
    s_add_u32 s47, s47, 0x20000
    s_add_u32 m0, s47, 0
    s_add_u32 s42, s36, 0
    buffer_load_dwordx4 v8, s[8:11], s42 offen nt lds
    s_add_u32 m0, s47, 0x4000
    s_add_u32 s42, s36, 0x80
    buffer_load_dwordx4 v8, s[8:11], s42 offen nt lds
    s_add_u32 m0, s47, 0x400
    s_add_u32 s42, s36, 0x800
    buffer_load_dwordx4 v9, s[8:11], s42 offen nt lds
    s_add_u32 m0, s47, 0x4400
    s_add_u32 s42, s36, 0x880
    buffer_load_dwordx4 v9, s[8:11], s42 offen nt lds
    s_add_u32 m0, s47, 0x800
    s_add_u32 s42, s36, 0x1000
    buffer_load_dwordx4 v8, s[8:11], s42 offen nt lds
    s_add_u32 m0, s47, 0x4800
    s_add_u32 s42, s36, 0x1080
    buffer_load_dwordx4 v8, s[8:11], s42 offen nt lds
    s_add_u32 m0, s47, 0xc00
    s_add_u32 s42, s36, 0x1800
    buffer_load_dwordx4 v9, s[8:11], s42 offen nt lds
    s_add_u32 m0, s47, 0x4c00
    s_add_u32 s42, s36, 0x1880
    buffer_load_dwordx4 v9, s[8:11], s42 offen nt lds
    s_mov_b32 s43, 4
    s_mov_b32 s38, 3
    s_mov_b64 vcc, -1
    s_mov_b32 s20, s26
    s_and_b32 s21, s27, 0xffff
    s_mov_b32 s22, 0
    s_mov_b32 s23, 0x20000
    s_mov_b32 s29, 0x4f800000
    s_lshl_b32 s35, s34, 12
    s_add_u32 s35, s35, 0x20000
    s_mov_b32 s47, s35
    v_xor_b32 v162, v161, v163
    v_lshlrev_b32 v8, 8, v160
    v_lshl_add_u32 v8, v162, 4, v8
    v_xor_b32 v9, 64, v8
    v_lshlrev_b32 v162, 1, v160
    v_and_b32 v162, 7, v162
    v_xor_b32 v162, v162, v161
    v_lshlrev_b32 v112, 9, v160
    v_lshl_add_u32 v112, v162, 4, v112
    v_add_u32 v112, s35, v112
    v_and_b32 v160, 15, v166
    v_bfe_u32 v162, v166, 1, 3
    v_lshlrev_b32 v6, 7, v160
    v_add_u32 v6, s35, v6
    v_lshlrev_b32 v7, 10, v163
    v_lshl_add_u32 v7, v160, 4, v7
    v_and_b32 v161, 1, v163
    v_xor_b32 v162, v162, v163
    v_lshl_add_u32 v6, v162, 4, v6
    v_xor_b32 v114, 64, v6
    v_mov_b32 v12, 0x3f803f80
    v_mov_b32 v13, 0x3f803f80
    v_mov_b32 v14, 0x3f803f80
    v_mov_b32 v15, 0x3f803f80
    v_lshrrev_b32 v162, 4, v166
    v_xor_b32 v162, v162, v166
    v_and_b32 v162, 2, v162
    v_lshrrev_b32 v162, 1, v162
    v_add_u32 v162, -1, v162
    v_and_b32 v28, 0x40804080, v162
    v_and_b32 v29, 0x40804080, v162
    v_and_b32 v30, 0x40804080, v162
    v_and_b32 v31, 0x40804080, v162
    v_and_b32 v162, 1, v166
    v_mul_u32_u24 v162, 0xaaaa, v162
    v_add_u32 v115, 0x4444, v162
    v_lshrrev_b32 v162, 3, v160
    v_lshlrev_b32 v1, 10, v162
    v_and_b32 v162, 7, v166
    v_lshl_add_u32 v1, v162, 4, v1
    v_lshl_add_u32 v1, v163, 7, v1
    v_bfe_u32 v162, v166, 2, 2
    v_mul_u32_u24 v2, 0x120, v162
    v_lshl_add_u32 v2, v161, 7, v2
    v_lshrrev_b32 v162, 5, v166
    v_lshl_add_u32 v2, v162, 11, v2
    v_and_b32 v162, 3, v166
    v_lshl_add_u32 v2, v162, 3, v2
    v_add_u32 v2, 0x10000, v2
    v_xor_b32 v3, 32, v2
    v_xor_b32 v4, 64, v2
    v_xor_b32 v5, 0x60, v2
    s_add_u32 s31, s36, 0x8000
    s_mov_b32 s32, s36
    s_mov_b32 s39, s36
    s_mov_b32 s30, 0
    s_mov_b32 s33, 0
    s_waitcnt vmcnt(0)
    ds_read_b128 v[64:67], v6
    ds_read_b128 v[80:83], v6 offset:2048
    ds_read_b128 v[68:71], v114
    ds_read_b128 v[84:87], v114 offset:2048
    ds_read_b128 v[72:75], v6 offset:16384
    ds_read_b128 v[88:91], v6 offset:18432
    ds_read_b128 v[76:79], v114 offset:16384
    ds_read_b128 v[92:95], v114 offset:18432
    s_waitcnt lgkmcnt(0)
    s_barrier
L_start:
    ds_read_b128 v[32:35], v1
    ds_read_b128 v[36:39], v1 offset:512
    ds_read_b128 v[40:43], v1 offset:4096
    ds_read_b128 v[44:47], v1 offset:4608
    ds_read_b128 v[48:51], v1 offset:2048
    ds_read_b128 v[52:55], v1 offset:2560
    ds_read_b128 v[56:59], v1 offset:6144
    ds_read_b128 v[60:63], v1 offset:6656
    s_add_u32 m0, s47, 0
    s_add_u32 s42, s31, 0
    s_waitcnt lgkmcnt(8)
    buffer_load_dwordx4 v8, s[8:11], s42 offen nt lds
    s_add_u32 m0, s47, 0x400
    s_add_u32 s42, s31, 0x800
    buffer_load_dwordx4 v9, s[8:11], s42 offen nt lds
    s_add_u32 m0, s47, 0x800
    s_add_u32 s42, s31, 0x1000
    buffer_load_dwordx4 v8, s[8:11], s42 offen nt lds
    s_add_u32 m0, s47, 0xc00
    s_add_u32 s42, s31, 0x1800
    buffer_load_dwordx4 v9, s[8:11], s42 offen nt lds
    v_mov_b32 v24, 0
    v_mov_b32 v25, 0
    v_mov_b32 v26, 0
    v_mov_b32 v27, 0
    v_mov_b32 v125, 0
    v_mov_b32 v126, 0
    v_mov_b32 v127, 0
    s_waitcnt lgkmcnt(7)
    v_mfma_f32_16x16x32_bf16 v[160:163], v[32:35], v[64:67], 0
    s_waitcnt lgkmcnt(6)
    v_mfma_f32_16x16x32_bf16 v[160:163], v[36:39], v[68:71], v[160:163]
    s_waitcnt lgkmcnt(5)
    v_mfma_f32_16x16x32_bf16 v[160:163], v[40:43], v[72:75], v[160:163]
    s_waitcnt lgkmcnt(4)
    v_mfma_f32_16x16x32_bf16 v[160:163], v[44:47], v[76:79], v[160:163]
    v_mfma_f32_16x16x32_bf16 v[164:167], v[32:35], v[80:83], 0
    ds_read_b128 v[32:35], v1 offset:8192
    v_mfma_f32_16x16x32_bf16 v[164:167], v[36:39], v[84:87], v[164:167]
    ds_read_b128 v[36:39], v1 offset:8704
    v_mfma_f32_16x16x32_bf16 v[164:167], v[40:43], v[88:91], v[164:167]
    ds_read_b128 v[40:43], v1 offset:12288
    v_mfma_f32_16x16x32_bf16 v[164:167], v[44:47], v[92:95], v[164:167]
    ds_read_b128 v[44:47], v1 offset:12800
    s_waitcnt lgkmcnt(7)
    v_mfma_f32_16x16x32_bf16 v[168:171], v[48:51], v[64:67], 0
    s_waitcnt lgkmcnt(6)
    v_mfma_f32_16x16x32_bf16 v[168:171], v[52:55], v[68:71], v[168:171]
    s_waitcnt lgkmcnt(5)
    v_mfma_f32_16x16x32_bf16 v[168:171], v[56:59], v[72:75], v[168:171]
    v_max3_f32 v10, v160, v161, v162
    v_max_f32 v10, v10, v163
    s_waitcnt lgkmcnt(4)
    v_mfma_f32_16x16x32_bf16 v[168:171], v[60:63], v[76:79], v[168:171]
    v_max3_f32 v11, v164, v165, v166
    v_max_f32 v11, v11, v167
    v_mfma_f32_16x16x32_bf16 v[172:175], v[48:51], v[80:83], 0
    ds_read_b128 v[48:51], v1 offset:10240
    v_permlane32_swap_b32 v10, v11
    v_max_f32 v10, v10, v11
    v_mfma_f32_16x16x32_bf16 v[172:175], v[52:55], v[84:87], v[172:175]
    ds_read_b128 v[52:55], v1 offset:10752
    v_mov_b32 v11, v10
    s_nop 1
    v_permlane16_swap_b32 v10, v11
    v_mfma_f32_16x16x32_bf16 v[172:175], v[56:59], v[88:91], v[172:175]
    ds_read_b128 v[56:59], v1 offset:14336
    v_max_f32 v10, v10, v11
    v_mov_b32 v11, v10
    v_mfma_f32_16x16x32_bf16 v[172:175], v[60:63], v[92:95], v[172:175]
    ds_read_b128 v[60:63], v1 offset:14848
    v_permlane32_swap_b32 v10, v11
    v_sub_f32 v16, 0, v10
    v_sub_f32 v17, 0, v10
    v_sub_f32 v18, 0, v10
    v_sub_f32 v19, 0, v10
    v_sub_f32 v20, 0, v11
    v_sub_f32 v21, 0, v11
    v_sub_f32 v22, 0, v11
    v_sub_f32 v23, 0, v11
L_first0:
    s_waitcnt lgkmcnt(4)
    v_mfma_f32_16x16x32_bf16 v[176:179], v[32:35], v[64:67], v[16:19]
    v_add_f32 v160, v160, v16
    v_add_f32 v161, v161, v16
    v_add_f32 v162, v162, v16
    v_mfma_f32_16x16x32_bf16 v[176:179], v[36:39], v[68:71], v[176:179]
    s_waitcnt lgkmcnt(0)
    ds_read_b128 v[60:63], v1 offset:14848
    v_add_f32 v163, v163, v16
    v_exp_f32 v160, v160
    v_mfma_f32_16x16x32_bf16 v[176:179], v[40:43], v[72:75], v[176:179]
    v_exp_f32 v161, v161
    v_add_f32 v164, v164, v20
    v_add_f32 v165, v165, v20
    v_mfma_f32_16x16x32_bf16 v[176:179], v[44:47], v[76:79], v[176:179]
    v_exp_f32 v162, v162
    v_exp_f32 v163, v163
    v_mfma_f32_16x16x32_bf16 v[180:183], v[32:35], v[80:83], v[20:23]
    s_cbranch_vccz L_inl1
    s_barrier
L_inl1:
    v_cvt_pk_bf16_f32 v160, v160, v161
    v_add_f32 v166, v166, v20
    v_add_f32 v167, v167, v20
    v_mfma_f32_16x16x32_bf16 v[180:183], v[36:39], v[84:87], v[180:183]
    ds_read_b64_tr_b16 v[32:33], v2
    ds_read_b64_tr_b16 v[34:35], v2 offset:4096
    v_exp_f32 v164, v164
    v_exp_f32 v165, v165
    v_mfma_f32_16x16x32_bf16 v[180:183], v[40:43], v[88:91], v[180:183]
    v_cvt_pk_bf16_f32 v161, v162, v163
    v_add_f32 v168, v168, v16
    v_add_f32 v169, v169, v16
    v_mfma_f32_16x16x32_bf16 v[180:183], v[44:47], v[92:95], v[180:183]
    ds_read_b64_tr_b16 v[36:37], v3
    ds_read_b64_tr_b16 v[38:39], v3 offset:4096
    v_exp_f32 v166, v166
    v_exp_f32 v167, v167
    s_waitcnt lgkmcnt(4)
    v_mfma_f32_16x16x32_bf16 v[184:187], v[48:51], v[64:67], v[16:19]
    v_cvt_pk_bf16_f32 v164, v164, v165
    v_add_f32 v170, v170, v16
    v_add_f32 v171, v171, v16
    v_mfma_f32_16x16x32_bf16 v[184:187], v[52:55], v[68:71], v[184:187]
    ds_read_b64_tr_b16 v[40:41], v4
    ds_read_b64_tr_b16 v[42:43], v4 offset:4096
    v_exp_f32 v168, v168
    v_exp_f32 v169, v169
    v_mfma_f32_16x16x32_bf16 v[184:187], v[56:59], v[72:75], v[184:187]
    v_cvt_pk_bf16_f32 v165, v166, v167
    v_add_f32 v172, v172, v20
    v_add_f32 v173, v173, v20
    v_mfma_f32_16x16x32_bf16 v[184:187], v[60:63], v[76:79], v[184:187]
    ds_read_b64_tr_b16 v[44:45], v5
    ds_read_b64_tr_b16 v[46:47], v5 offset:4096
    v_exp_f32 v170, v170
    v_exp_f32 v171, v171
    v_mfma_f32_16x16x32_bf16 v[188:191], v[48:51], v[80:83], v[20:23]
    v_cvt_pk_bf16_f32 v162, v168, v169
    v_add_f32 v174, v174, v20
    v_add_f32 v175, v175, v20
    v_mfma_f32_16x16x32_bf16 v[188:191], v[52:55], v[84:87], v[188:191]
    ds_read_b64_tr_b16 v[48:49], v2 offset:1024
    ds_read_b64_tr_b16 v[50:51], v2 offset:5120
    v_exp_f32 v172, v172
    v_exp_f32 v173, v173
    v_mfma_f32_16x16x32_bf16 v[188:191], v[56:59], v[88:91], v[188:191]
    v_cvt_pk_bf16_f32 v163, v170, v171
    v_exp_f32 v174, v174
    v_exp_f32 v175, v175
    v_mfma_f32_16x16x32_bf16 v[188:191], v[60:63], v[92:95], v[188:191]
    v_cvt_pk_bf16_f32 v166, v172, v173
    v_cvt_pk_bf16_f32 v167, v174, v175
    ds_read_b64_tr_b16 v[52:53], v3 offset:1024
    ds_read_b64_tr_b16 v[54:55], v3 offset:5120
L_first1:
    s_waitcnt lgkmcnt(4)
    v_smfmac_f32_16x16x64_bf16 v[24:27], v[28:31], v[160:167], v115
    ds_read_b64_tr_b16 v[56:57], v4 offset:1024
    ds_read_b64_tr_b16 v[58:59], v4 offset:5120
    v_mfma_f32_16x16x32_bf16 v[192:195], v[160:163], v[32:35], 0
    v_exp_f32 v176, v176
    v_mfma_f32_16x16x32_bf16 v[196:199], v[164:167], v[32:35], 0
    ds_read_b64_tr_b16 v[60:61], v5 offset:1024
    ds_read_b64_tr_b16 v[62:63], v5 offset:5120
    v_mfma_f32_16x16x32_bf16 v[200:203], v[160:163], v[36:39], 0
    v_exp_f32 v177, v177
    v_mfma_f32_16x16x32_bf16 v[204:207], v[164:167], v[36:39], 0
    ds_read_b128 v[32:35], v1 offset:16384
    v_cvt_pk_bf16_f32 v176, v176, v177
    v_mfma_f32_16x16x32_bf16 v[208:211], v[160:163], v[40:43], 0
    v_exp_f32 v178, v178
    v_mfma_f32_16x16x32_bf16 v[212:215], v[164:167], v[40:43], 0
    ds_read_b128 v[36:39], v1 offset:16896
    v_mfma_f32_16x16x32_bf16 v[216:219], v[160:163], v[44:47], 0
    v_exp_f32 v179, v179
    v_mfma_f32_16x16x32_bf16 v[220:223], v[164:167], v[44:47], 0
    ds_read_b128 v[40:43], v1 offset:20480
    s_waitcnt lgkmcnt(3)
    v_mfma_f32_16x16x32_bf16 v[224:227], v[160:163], v[48:51], 0
    v_exp_f32 v180, v180
    v_mfma_f32_16x16x32_bf16 v[228:231], v[164:167], v[48:51], 0
    ds_read_b128 v[44:47], v1 offset:20992
    v_cvt_pk_bf16_f32 v177, v178, v179
    v_mfma_f32_16x16x32_bf16 v[232:235], v[160:163], v[52:55], 0
    v_exp_f32 v181, v181
    v_mfma_f32_16x16x32_bf16 v[236:239], v[164:167], v[52:55], 0
    ds_read_b128 v[48:51], v1 offset:18432
    v_cvt_pk_bf16_f32 v180, v180, v181
    v_mfma_f32_16x16x32_bf16 v[240:243], v[160:163], v[56:59], 0
    v_exp_f32 v182, v182
    v_mfma_f32_16x16x32_bf16 v[244:247], v[164:167], v[56:59], 0
    ds_read_b128 v[52:55], v1 offset:18944
    v_mfma_f32_16x16x32_bf16 v[248:251], v[160:163], v[60:63], 0
    v_exp_f32 v183, v183
    v_mfma_f32_16x16x32_bf16 v[252:255], v[164:167], v[60:63], 0
    ds_read_b128 v[56:59], v1 offset:22528
    s_waitcnt lgkmcnt(3)
    v_mfma_f32_16x16x32_bf16 v[160:163], v[32:35], v[64:67], v[16:19]
    v_exp_f32 v184, v184
    v_mfma_f32_16x16x32_bf16 v[160:163], v[36:39], v[68:71], v[160:163]
    ds_read_b128 v[60:63], v1 offset:23040
    v_cvt_pk_bf16_f32 v181, v182, v183
    v_mfma_f32_16x16x32_bf16 v[160:163], v[40:43], v[72:75], v[160:163]
    v_exp_f32 v185, v185
    v_mfma_f32_16x16x32_bf16 v[160:163], v[44:47], v[76:79], v[160:163]
    buffer_store_dwordx4 v[128:131], v7, s[20:23], s32 offen sc1
    v_mfma_f32_16x16x32_bf16 v[164:167], v[32:35], v[80:83], v[20:23]
    s_cbranch_vccz L_inl2
    s_barrier
L_inl2:
    v_exp_f32 v186, v186
    v_cvt_pk_bf16_f32 v178, v184, v185
    v_mfma_f32_16x16x32_bf16 v[164:167], v[36:39], v[84:87], v[164:167]
    ds_read_b64_tr_b16 v[32:33], v2 offset:8192
    ds_read_b64_tr_b16 v[34:35], v2 offset:12288
    v_mfma_f32_16x16x32_bf16 v[164:167], v[40:43], v[88:91], v[164:167]
    v_exp_f32 v187, v187
    v_mfma_f32_16x16x32_bf16 v[164:167], v[44:47], v[92:95], v[164:167]
    ds_read_b64_tr_b16 v[36:37], v3 offset:8192
    ds_read_b64_tr_b16 v[38:39], v3 offset:12288
    s_waitcnt lgkmcnt(4)
    v_mfma_f32_16x16x32_bf16 v[168:171], v[48:51], v[64:67], v[16:19]
    v_exp_f32 v188, v188
    v_cvt_pk_bf16_f32 v179, v186, v187
    v_mfma_f32_16x16x32_bf16 v[168:171], v[52:55], v[68:71], v[168:171]
    ds_read_b64_tr_b16 v[40:41], v4 offset:8192
    ds_read_b64_tr_b16 v[42:43], v4 offset:12288
    v_mfma_f32_16x16x32_bf16 v[168:171], v[56:59], v[72:75], v[168:171]
    v_exp_f32 v189, v189
    v_mfma_f32_16x16x32_bf16 v[168:171], v[60:63], v[76:79], v[168:171]
    ds_read_b64_tr_b16 v[44:45], v5 offset:8192
    ds_read_b64_tr_b16 v[46:47], v5 offset:12288
    v_cvt_pk_bf16_f32 v182, v188, v189
    v_mfma_f32_16x16x32_bf16 v[172:175], v[48:51], v[80:83], v[20:23]
    v_exp_f32 v190, v190
    v_mfma_f32_16x16x32_bf16 v[172:175], v[52:55], v[84:87], v[172:175]
    ds_read_b64_tr_b16 v[48:49], v2 offset:9216
    ds_read_b64_tr_b16 v[50:51], v2 offset:13312
    v_mfma_f32_16x16x32_bf16 v[172:175], v[56:59], v[88:91], v[172:175]
    v_exp_f32 v191, v191
    v_mfma_f32_16x16x32_bf16 v[172:175], v[60:63], v[92:95], v[172:175]
    v_cvt_pk_bf16_f32 v183, v190, v191
    ds_read_b64_tr_b16 v[52:53], v3 offset:9216
    ds_read_b64_tr_b16 v[54:55], v3 offset:13312
    s_branch L_seg2
L_seg0:
    s_waitcnt lgkmcnt(4)
    v_smfmac_f32_16x16x64_bf16 v[24:27], v[28:31], v[176:183], v115
    ds_read_b64_tr_b16 v[56:57], v4 offset:58368
    ds_read_b64_tr_b16 v[58:59], v4 offset:62464
    v_add_f32 v160, v160, v16
    v_mfma_f32_16x16x32_bf16 v[192:195], v[176:179], v[32:35], v[192:195]
    s_setprio 0
    v_exp_f32 v160, v160
    v_add_f32 v161, v161, v16
    v_mfma_f32_16x16x32_bf16 v[196:199], v[180:183], v[32:35], v[196:199]
    ds_read_b64_tr_b16 v[60:61], v5 offset:58368
    ds_read_b64_tr_b16 v[62:63], v5 offset:62464
    v_add_f32 v162, v162, v16
    v_mfma_f32_16x16x32_bf16 v[200:203], v[176:179], v[36:39], v[200:203]
    v_exp_f32 v161, v161
    v_add_f32 v163, v163, v16
    v_add_f32 v10, v24, v25
    v_add_f32 v11, v26, v27
    v_max_f32 v0, v10, v11
    v_mfma_f32_16x16x32_bf16 v[204:207], v[180:183], v[36:39], v[204:207]
    ds_read_b128 v[32:35], v1 offset:8192
    v_add_f32 v164, v164, v20
    v_add_f32 v165, v165, v20
    v_cmp_nge_f32_e64 s[48:49], s29, v0
    v_rcp_f32 v10, v10
    v_mfma_f32_16x16x32_bf16 v[208:211], v[176:179], v[40:43], v[208:211]
    v_exp_f32 v162, v162
    v_add_f32 v166, v166, v20
    v_rcp_f32 v11, v11
    v_mfma_f32_16x16x32_bf16 v[212:215], v[180:183], v[40:43], v[212:215]
    ds_read_b128 v[36:39], v1 offset:8704
    v_add_f32 v167, v167, v20
    v_add_f32 v168, v168, v16
    v_cvt_pk_bf16_f32 v0, v10, v10
    v_and_b32 v0, 0xffff0000, v0
    v_mfma_f32_16x16x32_bf16 v[216:219], v[176:179], v[44:47], v[216:219]
    v_exp_f32 v163, v163
    v_add_f32 v169, v169, v16
    v_sub_f32 v0, v10, v0
    v_cvt_pk_bf16_f32 v124, v10, v0
    v_mfma_f32_16x16x32_bf16 v[220:223], v[180:183], v[44:47], v[220:223]
    ds_read_b128 v[40:43], v1 offset:12288
    v_cvt_pk_bf16_f32 v160, v160, v161
    v_mfma_f32_16x16x32_bf16 v[116:119], v[124:127], v[12:15], 0
    s_waitcnt lgkmcnt(3)
    v_mfma_f32_16x16x32_bf16 v[224:227], v[176:179], v[48:51], v[224:227]
    v_exp_f32 v164, v164
    v_cvt_pk_bf16_f32 v161, v162, v163
    v_cvt_pk_bf16_f32 v0, v11, v11
    v_and_b32 v0, 0xffff0000, v0
    v_sub_f32 v0, v11, v0
    v_cvt_pk_bf16_f32 v124, v11, v0
    v_mfma_f32_16x16x32_bf16 v[228:231], v[180:183], v[48:51], v[228:231]
    ds_read_b128 v[44:47], v1 offset:12800
    v_add_f32 v170, v170, v16
    v_mfma_f32_16x16x32_bf16 v[120:123], v[124:127], v[12:15], 0
    v_mfma_f32_16x16x32_bf16 v[232:235], v[176:179], v[52:55], v[232:235]
    v_exp_f32 v165, v165
    v_mov_b32 v24, 0
    v_mov_b32 v25, 0
    v_mfma_f32_16x16x32_bf16 v[236:239], v[180:183], v[52:55], v[236:239]
    ds_read_b128 v[48:51], v1 offset:10240
    v_add_f32 v171, v171, v16
    v_cvt_pk_bf16_f32 v164, v164, v165
    v_mov_b32 v26, 0
    v_mfma_f32_16x16x32_bf16 v[240:243], v[176:179], v[56:59], v[240:243]
    s_cmp_lg_u64 s[48:49], 0
    s_addc_u32 s33, s33, s33
    v_exp_f32 v166, v166
    v_mul_f32 v192, v192, v116
    v_mul_f32 v200, v200, v116
    v_mul_f32 v193, v193, v117
    v_mfma_f32_16x16x32_bf16 v[244:247], v[180:183], v[56:59], v[244:247]
    ds_read_b128 v[52:55], v1 offset:10752
    v_add_f32 v172, v172, v20
    v_mov_b32 v27, 0
    v_mul_f32 v201, v201, v117
    v_cvt_pk_bf16_f32 v128, v192, v200
    v_mul_f32 v194, v194, v118
    v_mfma_f32_16x16x32_bf16 v[248:251], v[176:179], v[60:63], v[248:251]
    v_exp_f32 v167, v167
    v_mul_f32 v202, v202, v118
    v_cvt_pk_bf16_f32 v132, v193, v201
    v_mul_f32 v195, v195, v119
    v_mul_f32 v203, v203, v119
    v_mfma_f32_16x16x32_bf16 v[252:255], v[180:183], v[60:63], v[252:255]
    ds_read_b128 v[56:59], v1 offset:14336
    v_cvt_pk_bf16_f32 v165, v166, v167
    v_cvt_pk_bf16_f32 v136, v194, v202
    v_mul_f32 v196, v196, v120
    v_mul_f32 v204, v204, v120
    s_waitcnt lgkmcnt(3)
    v_mfma_f32_16x16x32_bf16 v[176:179], v[32:35], v[64:67], v[16:19]
    v_exp_f32 v168, v168
    v_cvt_pk_bf16_f32 v140, v195, v203
    v_mul_f32 v197, v197, v121
    v_mul_f32 v205, v205, v121
    v_cvt_pk_bf16_f32 v144, v196, v204
    v_mfma_f32_16x16x32_bf16 v[176:179], v[36:39], v[68:71], v[176:179]
    ds_read_b128 v[60:63], v1 offset:14848
    v_add_f32 v173, v173, v20
    v_mul_f32 v198, v198, v122
    v_mul_f32 v206, v206, v122
    v_cvt_pk_bf16_f32 v148, v197, v205
    v_mul_f32 v199, v199, v123
    v_mfma_f32_16x16x32_bf16 v[176:179], v[40:43], v[72:75], v[176:179]
    v_exp_f32 v169, v169
    v_mul_f32 v207, v207, v123
    v_cvt_pk_bf16_f32 v152, v198, v206
    v_mul_f32 v208, v208, v116
    v_mul_f32 v216, v216, v116
    v_mfma_f32_16x16x32_bf16 v[176:179], v[44:47], v[76:79], v[176:179]
    v_add_f32 v174, v174, v20
    v_add_f32 v175, v175, v20
    v_cvt_pk_bf16_f32 v162, v168, v169
    v_cvt_pk_bf16_f32 v156, v199, v207
    v_mul_f32 v209, v209, v117
    v_mul_f32 v217, v217, v117
    v_mfma_f32_16x16x32_bf16 v[180:183], v[32:35], v[80:83], v[20:23]
    v_exp_f32 v170, v170
    v_cvt_pk_bf16_f32 v129, v208, v216
    v_mul_f32 v210, v210, v118
    v_mul_f32 v218, v218, v118
    v_cvt_pk_bf16_f32 v133, v209, v217
    v_mfma_f32_16x16x32_bf16 v[180:183], v[36:39], v[84:87], v[180:183]
    ds_read_b64_tr_b16 v[32:33], v2
    ds_read_b64_tr_b16 v[34:35], v2 offset:4096
    v_mul_f32 v211, v211, v119
    v_mul_f32 v219, v219, v119
    v_cvt_pk_bf16_f32 v137, v210, v218
    v_mfma_f32_16x16x32_bf16 v[180:183], v[40:43], v[88:91], v[180:183]
    v_exp_f32 v171, v171
    v_mul_f32 v212, v212, v120
    v_mul_f32 v220, v220, v120
    v_cvt_pk_bf16_f32 v141, v211, v219
    v_mfma_f32_16x16x32_bf16 v[180:183], v[44:47], v[92:95], v[180:183]
    ds_read_b64_tr_b16 v[36:37], v3
    ds_read_b64_tr_b16 v[38:39], v3 offset:4096
    v_mul_f32 v213, v213, v121
    v_mul_f32 v221, v221, v121
    s_waitcnt lgkmcnt(4)
    v_mfma_f32_16x16x32_bf16 v[184:187], v[48:51], v[64:67], v[16:19]
    v_exp_f32 v172, v172
    v_cvt_pk_bf16_f32 v163, v170, v171
    v_cvt_pk_bf16_f32 v145, v212, v220
    v_mul_f32 v214, v214, v122
    v_mfma_f32_16x16x32_bf16 v[184:187], v[52:55], v[68:71], v[184:187]
    ds_read_b64_tr_b16 v[40:41], v4
    ds_read_b64_tr_b16 v[42:43], v4 offset:4096
    v_mul_f32 v222, v222, v122
    v_cvt_pk_bf16_f32 v149, v213, v221
    v_mul_f32 v215, v215, v123
    v_mfma_f32_16x16x32_bf16 v[184:187], v[56:59], v[72:75], v[184:187]
    v_exp_f32 v173, v173
    v_mul_f32 v223, v223, v123
    v_cvt_pk_bf16_f32 v153, v214, v222
    v_mul_f32 v224, v224, v116
    v_mfma_f32_16x16x32_bf16 v[184:187], v[60:63], v[76:79], v[184:187]
    ds_read_b64_tr_b16 v[44:45], v5
    ds_read_b64_tr_b16 v[46:47], v5 offset:4096
    v_cvt_pk_bf16_f32 v166, v172, v173
    v_mul_f32 v232, v232, v116
    v_cvt_pk_bf16_f32 v157, v215, v223
    v_mfma_f32_16x16x32_bf16 v[188:191], v[48:51], v[80:83], v[20:23]
    v_exp_f32 v174, v174
    v_mul_f32 v225, v225, v117
    v_mul_f32 v233, v233, v117
    v_cvt_pk_bf16_f32 v130, v224, v232
    v_mfma_f32_16x16x32_bf16 v[188:191], v[52:55], v[84:87], v[188:191]
    ds_read_b64_tr_b16 v[48:49], v2 offset:1024
    ds_read_b64_tr_b16 v[50:51], v2 offset:5120
    v_mul_f32 v226, v226, v118
    v_mul_f32 v234, v234, v118
    v_cvt_pk_bf16_f32 v134, v225, v233
    v_mfma_f32_16x16x32_bf16 v[188:191], v[56:59], v[88:91], v[188:191]
    v_exp_f32 v175, v175
    v_mul_f32 v227, v227, v119
    v_mul_f32 v235, v235, v119
    v_cvt_pk_bf16_f32 v138, v226, v234
    v_mfma_f32_16x16x32_bf16 v[188:191], v[60:63], v[92:95], v[188:191]
    v_cvt_pk_bf16_f32 v167, v174, v175
    v_cvt_pk_bf16_f32 v142, v227, v235
    ds_read_b64_tr_b16 v[52:53], v3 offset:1024
    ds_read_b64_tr_b16 v[54:55], v3 offset:5120
L_seg1:
    s_waitcnt lgkmcnt(4)
    v_smfmac_f32_16x16x64_bf16 v[24:27], v[28:31], v[160:167], v115
    ds_read_b64_tr_b16 v[56:57], v4 offset:1024
    ds_read_b64_tr_b16 v[58:59], v4 offset:5120
    v_mul_f32 v228, v228, v120
    v_mul_f32 v236, v236, v120
    v_mul_f32 v229, v229, v121
    v_mfma_f32_16x16x32_bf16 v[192:195], v[160:163], v[32:35], 0
    v_exp_f32 v176, v176
    v_mul_f32 v237, v237, v121
    v_cvt_pk_bf16_f32 v146, v228, v236
    v_mul_f32 v230, v230, v122
    v_mfma_f32_16x16x32_bf16 v[196:199], v[164:167], v[32:35], 0
    ds_read_b64_tr_b16 v[60:61], v5 offset:1024
    ds_read_b64_tr_b16 v[62:63], v5 offset:5120
    v_mul_f32 v238, v238, v122
    v_cvt_pk_bf16_f32 v150, v229, v237
    v_mul_f32 v231, v231, v123
    v_mfma_f32_16x16x32_bf16 v[200:203], v[160:163], v[36:39], 0
    v_exp_f32 v177, v177
    v_mul_f32 v239, v239, v123
    v_cvt_pk_bf16_f32 v154, v230, v238
    v_mul_f32 v240, v240, v116
    v_mfma_f32_16x16x32_bf16 v[204:207], v[164:167], v[36:39], 0
    ds_read_b128 v[32:35], v1 offset:16384
    v_cvt_pk_bf16_f32 v176, v176, v177
    v_mul_f32 v248, v248, v116
    v_cvt_pk_bf16_f32 v158, v231, v239
    v_mul_f32 v241, v241, v117
    v_mfma_f32_16x16x32_bf16 v[208:211], v[160:163], v[40:43], 0
    v_exp_f32 v178, v178
    v_mul_f32 v249, v249, v117
    v_cvt_pk_bf16_f32 v131, v240, v248
    v_mul_f32 v242, v242, v118
    v_mfma_f32_16x16x32_bf16 v[212:215], v[164:167], v[40:43], 0
    ds_read_b128 v[36:39], v1 offset:16896
    v_mul_f32 v250, v250, v118
    v_cvt_pk_bf16_f32 v135, v241, v249
    v_mul_f32 v243, v243, v119
    v_mul_f32 v251, v251, v119
    v_mfma_f32_16x16x32_bf16 v[216:219], v[160:163], v[44:47], 0
    v_exp_f32 v179, v179
    v_cvt_pk_bf16_f32 v139, v242, v250
    v_mul_f32 v244, v244, v120
    v_mfma_f32_16x16x32_bf16 v[220:223], v[164:167], v[44:47], 0
    ds_read_b128 v[40:43], v1 offset:20480
    v_mul_f32 v252, v252, v120
    v_cvt_pk_bf16_f32 v143, v243, v251
    s_waitcnt lgkmcnt(3)
    v_mfma_f32_16x16x32_bf16 v[224:227], v[160:163], v[48:51], 0
    v_exp_f32 v180, v180
    v_mul_f32 v245, v245, v121
    v_mul_f32 v253, v253, v121
    v_mfma_f32_16x16x32_bf16 v[228:231], v[164:167], v[48:51], 0
    ds_read_b128 v[44:47], v1 offset:20992
    v_cvt_pk_bf16_f32 v177, v178, v179
    v_cvt_pk_bf16_f32 v147, v244, v252
    v_mul_f32 v246, v246, v122
    v_mfma_f32_16x16x32_bf16 v[232:235], v[160:163], v[52:55], 0
    v_exp_f32 v181, v181
    v_mul_f32 v254, v254, v122
    v_cvt_pk_bf16_f32 v151, v245, v253
    v_mfma_f32_16x16x32_bf16 v[236:239], v[164:167], v[52:55], 0
    ds_read_b128 v[48:51], v1 offset:18432
    v_cvt_pk_bf16_f32 v180, v180, v181
    v_mul_f32 v247, v247, v123
    v_mul_f32 v255, v255, v123
    v_mfma_f32_16x16x32_bf16 v[240:243], v[160:163], v[56:59], 0
    v_exp_f32 v182, v182
    v_cvt_pk_bf16_f32 v155, v246, v254
    v_cvt_pk_bf16_f32 v159, v247, v255
    v_mfma_f32_16x16x32_bf16 v[244:247], v[164:167], v[56:59], 0
    ds_read_b128 v[52:55], v1 offset:18944
    v_mfma_f32_16x16x32_bf16 v[248:251], v[160:163], v[60:63], 0
    v_exp_f32 v183, v183
    v_mfma_f32_16x16x32_bf16 v[252:255], v[164:167], v[60:63], 0
    ds_read_b128 v[56:59], v1 offset:22528
    s_waitcnt lgkmcnt(3)
    v_mfma_f32_16x16x32_bf16 v[160:163], v[32:35], v[64:67], v[16:19]
    v_exp_f32 v184, v184
    v_mfma_f32_16x16x32_bf16 v[160:163], v[36:39], v[68:71], v[160:163]
    ds_read_b128 v[60:63], v1 offset:23040
    v_cvt_pk_bf16_f32 v181, v182, v183
    v_mfma_f32_16x16x32_bf16 v[160:163], v[40:43], v[72:75], v[160:163]
    v_exp_f32 v185, v185
    v_mfma_f32_16x16x32_bf16 v[160:163], v[44:47], v[76:79], v[160:163]
    buffer_store_dwordx4 v[128:131], v7, s[20:23], s32 offen sc1
    v_mfma_f32_16x16x32_bf16 v[164:167], v[32:35], v[80:83], v[20:23]
    v_exp_f32 v186, v186
    v_cvt_pk_bf16_f32 v178, v184, v185
    v_mfma_f32_16x16x32_bf16 v[164:167], v[36:39], v[84:87], v[164:167]
    ds_read_b64_tr_b16 v[32:33], v2 offset:8192
    ds_read_b64_tr_b16 v[34:35], v2 offset:12288
    v_mfma_f32_16x16x32_bf16 v[164:167], v[40:43], v[88:91], v[164:167]
    v_exp_f32 v187, v187
    v_mfma_f32_16x16x32_bf16 v[164:167], v[44:47], v[92:95], v[164:167]
    ds_read_b64_tr_b16 v[36:37], v3 offset:8192
    ds_read_b64_tr_b16 v[38:39], v3 offset:12288
    s_waitcnt lgkmcnt(4)
    v_mfma_f32_16x16x32_bf16 v[168:171], v[48:51], v[64:67], v[16:19]
    v_exp_f32 v188, v188
    v_cvt_pk_bf16_f32 v179, v186, v187
    v_mfma_f32_16x16x32_bf16 v[168:171], v[52:55], v[68:71], v[168:171]
    ds_read_b64_tr_b16 v[40:41], v4 offset:8192
    ds_read_b64_tr_b16 v[42:43], v4 offset:12288
    v_mfma_f32_16x16x32_bf16 v[168:171], v[56:59], v[72:75], v[168:171]
    v_exp_f32 v189, v189
    v_mfma_f32_16x16x32_bf16 v[168:171], v[60:63], v[76:79], v[168:171]
    ds_read_b64_tr_b16 v[44:45], v5 offset:8192
    ds_read_b64_tr_b16 v[46:47], v5 offset:12288
    v_cvt_pk_bf16_f32 v182, v188, v189
    v_mfma_f32_16x16x32_bf16 v[172:175], v[48:51], v[80:83], v[20:23]
    v_exp_f32 v190, v190
    v_mfma_f32_16x16x32_bf16 v[172:175], v[52:55], v[84:87], v[172:175]
    ds_read_b64_tr_b16 v[48:49], v2 offset:9216
    ds_read_b64_tr_b16 v[50:51], v2 offset:13312
    v_mfma_f32_16x16x32_bf16 v[172:175], v[56:59], v[88:91], v[172:175]
    v_exp_f32 v191, v191
    v_mfma_f32_16x16x32_bf16 v[172:175], v[60:63], v[92:95], v[172:175]
    v_cvt_pk_bf16_f32 v183, v190, v191
    ds_read_b64_tr_b16 v[52:53], v3 offset:9216
    ds_read_b64_tr_b16 v[54:55], v3 offset:13312
L_seg2:
    s_waitcnt lgkmcnt(4)
    v_smfmac_f32_16x16x64_bf16 v[24:27], v[28:31], v[176:183], v115
    ds_read_b64_tr_b16 v[56:57], v4 offset:9216
    ds_read_b64_tr_b16 v[58:59], v4 offset:13312
    v_mfma_f32_16x16x32_bf16 v[192:195], v[176:179], v[32:35], v[192:195]
    s_setprio 3
    v_exp_f32 v160, v160
    v_mfma_f32_16x16x32_bf16 v[196:199], v[180:183], v[32:35], v[196:199]
    ds_read_b64_tr_b16 v[60:61], v5 offset:9216
    ds_read_b64_tr_b16 v[62:63], v5 offset:13312
    v_mfma_f32_16x16x32_bf16 v[200:203], v[176:179], v[36:39], v[200:203]
    v_exp_f32 v161, v161
    v_mfma_f32_16x16x32_bf16 v[204:207], v[180:183], v[36:39], v[204:207]
    ds_read_b128 v[32:35], v1 offset:24576
    v_cvt_pk_bf16_f32 v160, v160, v161
    v_mfma_f32_16x16x32_bf16 v[208:211], v[176:179], v[40:43], v[208:211]
    v_exp_f32 v162, v162
    v_mfma_f32_16x16x32_bf16 v[212:215], v[180:183], v[40:43], v[212:215]
    ds_read_b128 v[36:39], v1 offset:25088
    buffer_store_dwordx4 v[132:135], v7, s[20:23], s32 offen offset:256 sc1
    v_mfma_f32_16x16x32_bf16 v[216:219], v[176:179], v[44:47], v[216:219]
    v_exp_f32 v163, v163
    v_mfma_f32_16x16x32_bf16 v[220:223], v[180:183], v[44:47], v[220:223]
    ds_read_b128 v[40:43], v1 offset:28672
    s_waitcnt lgkmcnt(3)
    v_mfma_f32_16x16x32_bf16 v[224:227], v[176:179], v[48:51], v[224:227]
    v_exp_f32 v164, v164
    v_mfma_f32_16x16x32_bf16 v[228:231], v[180:183], v[48:51], v[228:231]
    ds_read_b128 v[44:47], v1 offset:29184
    v_cvt_pk_bf16_f32 v161, v162, v163
    v_mfma_f32_16x16x32_bf16 v[232:235], v[176:179], v[52:55], v[232:235]
    v_exp_f32 v165, v165
    v_mfma_f32_16x16x32_bf16 v[236:239], v[180:183], v[52:55], v[236:239]
    ds_read_b128 v[48:51], v1 offset:26624
    s_waitcnt vmcnt(2)
    ds_read_b128 v[96:99], v6
    v_mfma_f32_16x16x32_bf16 v[240:243], v[176:179], v[56:59], v[240:243]
    v_exp_f32 v166, v166
    v_cvt_pk_bf16_f32 v164, v164, v165
    v_mfma_f32_16x16x32_bf16 v[244:247], v[180:183], v[56:59], v[244:247]
    ds_read_b128 v[52:55], v1 offset:27136
    ds_read_b128 v[104:107], v6 offset:2048
    v_mfma_f32_16x16x32_bf16 v[248:251], v[176:179], v[60:63], v[248:251]
    v_exp_f32 v167, v167
    v_mfma_f32_16x16x32_bf16 v[252:255], v[180:183], v[60:63], v[252:255]
    ds_read_b128 v[56:59], v1 offset:30720
    ds_read_b128 v[100:103], v114
    s_waitcnt lgkmcnt(6)
    v_mfma_f32_16x16x32_bf16 v[176:179], v[32:35], v[64:67], v[16:19]
    v_exp_f32 v168, v168
    v_mfma_f32_16x16x32_bf16 v[176:179], v[36:39], v[68:71], v[176:179]
    ds_read_b128 v[60:63], v1 offset:31232
    ds_read_b128 v[108:111], v114 offset:2048
    v_mfma_f32_16x16x32_bf16 v[176:179], v[40:43], v[72:75], v[176:179]
    v_exp_f32 v169, v169
    v_mfma_f32_16x16x32_bf16 v[176:179], v[44:47], v[76:79], v[176:179]
    v_cvt_pk_bf16_f32 v165, v166, v167
    v_cvt_pk_bf16_f32 v162, v168, v169
    v_mfma_f32_16x16x32_bf16 v[180:183], v[32:35], v[80:83], v[20:23]
    v_exp_f32 v170, v170
    v_mfma_f32_16x16x32_bf16 v[180:183], v[36:39], v[84:87], v[180:183]
    ds_read_b64_tr_b16 v[32:33], v2 offset:16384
    ds_read_b64_tr_b16 v[34:35], v2 offset:20480
    v_mfma_f32_16x16x32_bf16 v[180:183], v[40:43], v[88:91], v[180:183]
    v_exp_f32 v171, v171
    v_mfma_f32_16x16x32_bf16 v[180:183], v[44:47], v[92:95], v[180:183]
    ds_read_b64_tr_b16 v[36:37], v3 offset:16384
    ds_read_b64_tr_b16 v[38:39], v3 offset:20480
    s_waitcnt lgkmcnt(5)
    v_mfma_f32_16x16x32_bf16 v[184:187], v[48:51], v[64:67], v[16:19]
    v_exp_f32 v172, v172
    v_cvt_pk_bf16_f32 v163, v170, v171
    v_mfma_f32_16x16x32_bf16 v[184:187], v[52:55], v[68:71], v[184:187]
    ds_read_b64_tr_b16 v[40:41], v4 offset:16384
    ds_read_b64_tr_b16 v[42:43], v4 offset:20480
    v_mfma_f32_16x16x32_bf16 v[184:187], v[56:59], v[72:75], v[184:187]
    v_exp_f32 v173, v173
    v_mfma_f32_16x16x32_bf16 v[184:187], v[60:63], v[76:79], v[184:187]
    ds_read_b64_tr_b16 v[44:45], v5 offset:16384
    ds_read_b64_tr_b16 v[46:47], v5 offset:20480
    v_cvt_pk_bf16_f32 v166, v172, v173
    v_mfma_f32_16x16x32_bf16 v[188:191], v[48:51], v[80:83], v[20:23]
    v_exp_f32 v174, v174
    v_mfma_f32_16x16x32_bf16 v[188:191], v[52:55], v[84:87], v[188:191]
    ds_read_b64_tr_b16 v[48:49], v2 offset:17408
    ds_read_b64_tr_b16 v[50:51], v2 offset:21504
    v_mfma_f32_16x16x32_bf16 v[188:191], v[56:59], v[88:91], v[188:191]
    v_exp_f32 v175, v175
    v_mfma_f32_16x16x32_bf16 v[188:191], v[60:63], v[92:95], v[188:191]
    v_cvt_pk_bf16_f32 v167, v174, v175
    ds_read_b64_tr_b16 v[52:53], v3 offset:17408
    ds_read_b64_tr_b16 v[54:55], v3 offset:21504
L_seg3:
    s_waitcnt lgkmcnt(4)
    v_smfmac_f32_16x16x64_bf16 v[24:27], v[28:31], v[160:167], v115
    ds_read_b64_tr_b16 v[56:57], v4 offset:17408
    ds_read_b64_tr_b16 v[58:59], v4 offset:21504
    v_mfma_f32_16x16x32_bf16 v[192:195], v[160:163], v[32:35], v[192:195]
    v_exp_f32 v176, v176
    v_mfma_f32_16x16x32_bf16 v[196:199], v[164:167], v[32:35], v[196:199]
    ds_read_b64_tr_b16 v[60:61], v5 offset:17408
    ds_read_b64_tr_b16 v[62:63], v5 offset:21504
    v_mfma_f32_16x16x32_bf16 v[200:203], v[160:163], v[36:39], v[200:203]
    s_add_u32 m0, s47, 0
    v_exp_f32 v177, v177
    v_mfma_f32_16x16x32_bf16 v[204:207], v[164:167], v[36:39], v[204:207]
    s_add_u32 s42, s31, 0x80
    ds_read_b128 v[32:35], v1 offset:32768
    buffer_load_dwordx4 v8, s[8:11], s42 offen nt lds
    v_mfma_f32_16x16x32_bf16 v[208:211], v[160:163], v[40:43], v[208:211]
    v_exp_f32 v178, v178
    v_mfma_f32_16x16x32_bf16 v[212:215], v[164:167], v[40:43], v[212:215]
    ds_read_b128 v[36:39], v1 offset:33280
    v_cvt_pk_bf16_f32 v176, v176, v177
    v_mfma_f32_16x16x32_bf16 v[216:219], v[160:163], v[44:47], v[216:219]
    v_exp_f32 v179, v179
    v_mfma_f32_16x16x32_bf16 v[220:223], v[164:167], v[44:47], v[220:223]
    ds_read_b128 v[40:43], v1 offset:36864
    v_cvt_pk_bf16_f32 v177, v178, v179
    s_waitcnt lgkmcnt(3)
    v_mfma_f32_16x16x32_bf16 v[224:227], v[160:163], v[48:51], v[224:227]
    s_add_u32 m0, s47, 0x400
    v_exp_f32 v180, v180
    v_mfma_f32_16x16x32_bf16 v[228:231], v[164:167], v[48:51], v[228:231]
    s_add_u32 s42, s31, 0x880
    ds_read_b128 v[44:47], v1 offset:37376
    buffer_load_dwordx4 v9, s[8:11], s42 offen nt lds
    v_mfma_f32_16x16x32_bf16 v[232:235], v[160:163], v[52:55], v[232:235]
    v_exp_f32 v181, v181
    v_mfma_f32_16x16x32_bf16 v[236:239], v[164:167], v[52:55], v[236:239]
    ds_read_b128 v[48:51], v1 offset:34816
    v_cvt_pk_bf16_f32 v180, v180, v181
    v_mfma_f32_16x16x32_bf16 v[240:243], v[160:163], v[56:59], v[240:243]
    s_add_u32 m0, s47, 0x800
    v_exp_f32 v182, v182
    v_mfma_f32_16x16x32_bf16 v[244:247], v[164:167], v[56:59], v[244:247]
    s_add_u32 s42, s31, 0x1080
    ds_read_b128 v[52:55], v1 offset:35328
    buffer_load_dwordx4 v8, s[8:11], s42 offen nt lds
    v_mfma_f32_16x16x32_bf16 v[248:251], v[160:163], v[60:63], v[248:251]
    v_exp_f32 v183, v183
    v_mfma_f32_16x16x32_bf16 v[252:255], v[164:167], v[60:63], v[252:255]
    ds_read_b128 v[56:59], v1 offset:38912
    s_waitcnt lgkmcnt(3)
    v_mfma_f32_16x16x32_bf16 v[160:163], v[32:35], v[64:67], v[16:19]
    s_add_u32 m0, s47, 0xc00
    v_exp_f32 v184, v184
    v_mfma_f32_16x16x32_bf16 v[160:163], v[36:39], v[68:71], v[160:163]
    s_add_u32 s42, s31, 0x1880
    ds_read_b128 v[60:63], v1 offset:39424
    buffer_load_dwordx4 v9, s[8:11], s42 offen nt lds
    v_mfma_f32_16x16x32_bf16 v[160:163], v[40:43], v[72:75], v[160:163]
    v_exp_f32 v185, v185
    v_mfma_f32_16x16x32_bf16 v[160:163], v[44:47], v[76:79], v[160:163]
    v_cvt_pk_bf16_f32 v181, v182, v183
    v_cvt_pk_bf16_f32 v178, v184, v185
    v_mfma_f32_16x16x32_bf16 v[164:167], v[32:35], v[80:83], v[20:23]
    s_cbranch_vccnz L_sync0
L_back0:
    v_exp_f32 v186, v186
    v_mfma_f32_16x16x32_bf16 v[164:167], v[36:39], v[84:87], v[164:167]
    ds_read_b64_tr_b16 v[32:33], v2 offset:24576
    ds_read_b64_tr_b16 v[34:35], v2 offset:28672
    v_mfma_f32_16x16x32_bf16 v[164:167], v[40:43], v[88:91], v[164:167]
    v_exp_f32 v187, v187
    v_mfma_f32_16x16x32_bf16 v[164:167], v[44:47], v[92:95], v[164:167]
    ds_read_b64_tr_b16 v[36:37], v3 offset:24576
    ds_read_b64_tr_b16 v[38:39], v3 offset:28672
    s_waitcnt lgkmcnt(4)
    v_mfma_f32_16x16x32_bf16 v[168:171], v[48:51], v[64:67], v[16:19]
    v_exp_f32 v188, v188
    v_cvt_pk_bf16_f32 v179, v186, v187
    v_mfma_f32_16x16x32_bf16 v[168:171], v[52:55], v[68:71], v[168:171]
    ds_read_b64_tr_b16 v[40:41], v4 offset:24576
    ds_read_b64_tr_b16 v[42:43], v4 offset:28672
    v_mfma_f32_16x16x32_bf16 v[168:171], v[56:59], v[72:75], v[168:171]
    v_exp_f32 v189, v189
    v_mfma_f32_16x16x32_bf16 v[168:171], v[60:63], v[76:79], v[168:171]
    ds_read_b64_tr_b16 v[44:45], v5 offset:24576
    ds_read_b64_tr_b16 v[46:47], v5 offset:28672
    v_cvt_pk_bf16_f32 v182, v188, v189
    v_mfma_f32_16x16x32_bf16 v[172:175], v[48:51], v[80:83], v[20:23]
    v_exp_f32 v190, v190
    v_mfma_f32_16x16x32_bf16 v[172:175], v[52:55], v[84:87], v[172:175]
    ds_read_b64_tr_b16 v[48:49], v2 offset:25600
    ds_read_b64_tr_b16 v[50:51], v2 offset:29696
    v_mfma_f32_16x16x32_bf16 v[172:175], v[56:59], v[88:91], v[172:175]
    v_exp_f32 v191, v191
    v_mfma_f32_16x16x32_bf16 v[172:175], v[60:63], v[92:95], v[172:175]
    v_cvt_pk_bf16_f32 v183, v190, v191
    ds_read_b64_tr_b16 v[52:53], v3 offset:25600
    ds_read_b64_tr_b16 v[54:55], v3 offset:29696
L_seg4:
    s_waitcnt lgkmcnt(4)
    v_smfmac_f32_16x16x64_bf16 v[24:27], v[28:31], v[176:183], v115
    ds_read_b64_tr_b16 v[56:57], v4 offset:25600
    ds_read_b64_tr_b16 v[58:59], v4 offset:29696
    v_mfma_f32_16x16x32_bf16 v[192:195], v[176:179], v[32:35], v[192:195]
    s_setprio 2
    v_exp_f32 v160, v160
    v_mfma_f32_16x16x32_bf16 v[196:199], v[180:183], v[32:35], v[196:199]
    ds_read_b64_tr_b16 v[60:61], v5 offset:25600
    ds_read_b64_tr_b16 v[62:63], v5 offset:29696
    v_mfma_f32_16x16x32_bf16 v[200:203], v[176:179], v[36:39], v[200:203]
    v_exp_f32 v161, v161
    v_mfma_f32_16x16x32_bf16 v[204:207], v[180:183], v[36:39], v[204:207]
    ds_read_b128 v[32:35], v1 offset:40960
    v_cvt_pk_bf16_f32 v160, v160, v161
    v_mfma_f32_16x16x32_bf16 v[208:211], v[176:179], v[40:43], v[208:211]
    v_exp_f32 v162, v162
    v_mfma_f32_16x16x32_bf16 v[212:215], v[180:183], v[40:43], v[212:215]
    ds_read_b128 v[36:39], v1 offset:41472
    buffer_store_dwordx4 v[136:139], v7, s[20:23], s32 offen offset:512 sc1
    v_mfma_f32_16x16x32_bf16 v[216:219], v[176:179], v[44:47], v[216:219]
    v_exp_f32 v163, v163
    v_mfma_f32_16x16x32_bf16 v[220:223], v[180:183], v[44:47], v[220:223]
    ds_read_b128 v[40:43], v1 offset:45056
    s_waitcnt lgkmcnt(3)
    v_mfma_f32_16x16x32_bf16 v[224:227], v[176:179], v[48:51], v[224:227]
    v_exp_f32 v164, v164
    v_mfma_f32_16x16x32_bf16 v[228:231], v[180:183], v[48:51], v[228:231]
    ds_read_b128 v[44:47], v1 offset:45568
    v_cvt_pk_bf16_f32 v161, v162, v163
    v_mfma_f32_16x16x32_bf16 v[232:235], v[176:179], v[52:55], v[232:235]
    v_exp_f32 v165, v165
    v_mfma_f32_16x16x32_bf16 v[236:239], v[180:183], v[52:55], v[236:239]
    ds_read_b128 v[48:51], v1 offset:43008
    v_cvt_pk_bf16_f32 v164, v164, v165
    v_mfma_f32_16x16x32_bf16 v[240:243], v[176:179], v[56:59], v[240:243]
    v_exp_f32 v166, v166
    v_mfma_f32_16x16x32_bf16 v[244:247], v[180:183], v[56:59], v[244:247]
    ds_read_b128 v[52:55], v1 offset:43520
    v_mfma_f32_16x16x32_bf16 v[248:251], v[176:179], v[60:63], v[248:251]
    v_exp_f32 v167, v167
    v_mfma_f32_16x16x32_bf16 v[252:255], v[180:183], v[60:63], v[252:255]
    ds_read_b128 v[56:59], v1 offset:47104
    s_waitcnt lgkmcnt(3)
    v_mfma_f32_16x16x32_bf16 v[176:179], v[32:35], v[64:67], v[16:19]
    v_exp_f32 v168, v168
    v_mfma_f32_16x16x32_bf16 v[176:179], v[36:39], v[68:71], v[176:179]
    ds_read_b128 v[60:63], v1 offset:47616
    v_cvt_pk_bf16_f32 v165, v166, v167
    v_mfma_f32_16x16x32_bf16 v[176:179], v[40:43], v[72:75], v[176:179]
    v_exp_f32 v169, v169
    v_mfma_f32_16x16x32_bf16 v[176:179], v[44:47], v[76:79], v[176:179]
    buffer_store_dwordx4 v[140:143], v7, s[20:23], s32 offen offset:768 sc1
    v_mfma_f32_16x16x32_bf16 v[180:183], v[32:35], v[80:83], v[20:23]
    v_exp_f32 v170, v170
    v_cvt_pk_bf16_f32 v162, v168, v169
    v_mfma_f32_16x16x32_bf16 v[180:183], v[36:39], v[84:87], v[180:183]
    ds_read_b64_tr_b16 v[32:33], v2 offset:32768
    ds_read_b64_tr_b16 v[34:35], v2 offset:36864
    v_mfma_f32_16x16x32_bf16 v[180:183], v[40:43], v[88:91], v[180:183]
    v_exp_f32 v171, v171
    v_mfma_f32_16x16x32_bf16 v[180:183], v[44:47], v[92:95], v[180:183]
    ds_read_b64_tr_b16 v[36:37], v3 offset:32768
    ds_read_b64_tr_b16 v[38:39], v3 offset:36864
    s_waitcnt lgkmcnt(4)
    v_mfma_f32_16x16x32_bf16 v[184:187], v[48:51], v[64:67], v[16:19]
    v_exp_f32 v172, v172
    v_cvt_pk_bf16_f32 v163, v170, v171
    v_mfma_f32_16x16x32_bf16 v[184:187], v[52:55], v[68:71], v[184:187]
    ds_read_b64_tr_b16 v[40:41], v4 offset:32768
    ds_read_b64_tr_b16 v[42:43], v4 offset:36864
    v_mfma_f32_16x16x32_bf16 v[184:187], v[56:59], v[72:75], v[184:187]
    v_exp_f32 v173, v173
    v_mfma_f32_16x16x32_bf16 v[184:187], v[60:63], v[76:79], v[184:187]
    ds_read_b64_tr_b16 v[44:45], v5 offset:32768
    ds_read_b64_tr_b16 v[46:47], v5 offset:36864
    v_cvt_pk_bf16_f32 v166, v172, v173
    v_mfma_f32_16x16x32_bf16 v[188:191], v[48:51], v[80:83], v[20:23]
    v_exp_f32 v174, v174
    v_mfma_f32_16x16x32_bf16 v[188:191], v[52:55], v[84:87], v[188:191]
    ds_read_b64_tr_b16 v[48:49], v2 offset:33792
    ds_read_b64_tr_b16 v[50:51], v2 offset:37888
    v_mfma_f32_16x16x32_bf16 v[188:191], v[56:59], v[88:91], v[188:191]
    v_exp_f32 v175, v175
    v_mfma_f32_16x16x32_bf16 v[188:191], v[60:63], v[92:95], v[188:191]
    v_cvt_pk_bf16_f32 v167, v174, v175
    ds_read_b64_tr_b16 v[52:53], v3 offset:33792
    ds_read_b64_tr_b16 v[54:55], v3 offset:37888
L_seg5:
    s_waitcnt lgkmcnt(4)
    v_smfmac_f32_16x16x64_bf16 v[24:27], v[28:31], v[160:167], v115
    ds_read_b64_tr_b16 v[56:57], v4 offset:33792
    ds_read_b64_tr_b16 v[58:59], v4 offset:37888
    v_mfma_f32_16x16x32_bf16 v[192:195], v[160:163], v[32:35], v[192:195]
    v_exp_f32 v176, v176
    v_mfma_f32_16x16x32_bf16 v[196:199], v[164:167], v[32:35], v[196:199]
    ds_read_b64_tr_b16 v[60:61], v5 offset:33792
    ds_read_b64_tr_b16 v[62:63], v5 offset:37888
    v_mfma_f32_16x16x32_bf16 v[200:203], v[160:163], v[36:39], v[200:203]
    v_exp_f32 v177, v177
    v_mfma_f32_16x16x32_bf16 v[204:207], v[164:167], v[36:39], v[204:207]
    ds_read_b128 v[32:35], v1 offset:49152
    v_cvt_pk_bf16_f32 v176, v176, v177
    v_mfma_f32_16x16x32_bf16 v[208:211], v[160:163], v[40:43], v[208:211]
    v_exp_f32 v178, v178
    v_mfma_f32_16x16x32_bf16 v[212:215], v[164:167], v[40:43], v[212:215]
    ds_read_b128 v[36:39], v1 offset:49664
    buffer_store_dwordx4 v[144:147], v7, s[20:23], s39 offen sc1
    v_mfma_f32_16x16x32_bf16 v[216:219], v[160:163], v[44:47], v[216:219]
    v_exp_f32 v179, v179
    v_mfma_f32_16x16x32_bf16 v[220:223], v[164:167], v[44:47], v[220:223]
    ds_read_b128 v[40:43], v1 offset:53248
    s_waitcnt lgkmcnt(3)
    v_mfma_f32_16x16x32_bf16 v[224:227], v[160:163], v[48:51], v[224:227]
    v_exp_f32 v180, v180
    v_mfma_f32_16x16x32_bf16 v[228:231], v[164:167], v[48:51], v[228:231]
    ds_read_b128 v[44:47], v1 offset:53760
    v_cvt_pk_bf16_f32 v177, v178, v179
    v_mfma_f32_16x16x32_bf16 v[232:235], v[160:163], v[52:55], v[232:235]
    v_exp_f32 v181, v181
    v_mfma_f32_16x16x32_bf16 v[236:239], v[164:167], v[52:55], v[236:239]
    ds_read_b128 v[48:51], v1 offset:51200
    v_cvt_pk_bf16_f32 v180, v180, v181
    v_mfma_f32_16x16x32_bf16 v[240:243], v[160:163], v[56:59], v[240:243]
    v_exp_f32 v182, v182
    v_mfma_f32_16x16x32_bf16 v[244:247], v[164:167], v[56:59], v[244:247]
    ds_read_b128 v[52:55], v1 offset:51712
    v_mfma_f32_16x16x32_bf16 v[248:251], v[160:163], v[60:63], v[248:251]
    v_exp_f32 v183, v183
    v_mfma_f32_16x16x32_bf16 v[252:255], v[164:167], v[60:63], v[252:255]
    ds_read_b128 v[56:59], v1 offset:55296
    s_waitcnt lgkmcnt(3)
    v_mfma_f32_16x16x32_bf16 v[160:163], v[32:35], v[64:67], v[16:19]
    v_exp_f32 v184, v184
    v_mfma_f32_16x16x32_bf16 v[160:163], v[36:39], v[68:71], v[160:163]
    ds_read_b128 v[60:63], v1 offset:55808
    v_cvt_pk_bf16_f32 v181, v182, v183
    v_mfma_f32_16x16x32_bf16 v[160:163], v[40:43], v[72:75], v[160:163]
    v_exp_f32 v185, v185
    v_mfma_f32_16x16x32_bf16 v[160:163], v[44:47], v[76:79], v[160:163]
    buffer_store_dwordx4 v[148:151], v7, s[20:23], s39 offen offset:256 sc1
    v_mfma_f32_16x16x32_bf16 v[164:167], v[32:35], v[80:83], v[20:23]
    s_cbranch_vccnz L_sync1
L_back1:
    v_exp_f32 v186, v186
    v_cvt_pk_bf16_f32 v178, v184, v185
    v_mfma_f32_16x16x32_bf16 v[164:167], v[36:39], v[84:87], v[164:167]
    ds_read_b64_tr_b16 v[32:33], v2 offset:40960
    ds_read_b64_tr_b16 v[34:35], v2 offset:45056
    v_mfma_f32_16x16x32_bf16 v[164:167], v[40:43], v[88:91], v[164:167]
    v_exp_f32 v187, v187
    v_mfma_f32_16x16x32_bf16 v[164:167], v[44:47], v[92:95], v[164:167]
    ds_read_b64_tr_b16 v[36:37], v3 offset:40960
    ds_read_b64_tr_b16 v[38:39], v3 offset:45056
    s_waitcnt lgkmcnt(4)
    v_mfma_f32_16x16x32_bf16 v[168:171], v[48:51], v[64:67], v[16:19]
    v_exp_f32 v188, v188
    v_cvt_pk_bf16_f32 v179, v186, v187
    v_mfma_f32_16x16x32_bf16 v[168:171], v[52:55], v[68:71], v[168:171]
    ds_read_b64_tr_b16 v[40:41], v4 offset:40960
    ds_read_b64_tr_b16 v[42:43], v4 offset:45056
    v_mfma_f32_16x16x32_bf16 v[168:171], v[56:59], v[72:75], v[168:171]
    v_exp_f32 v189, v189
    v_mfma_f32_16x16x32_bf16 v[168:171], v[60:63], v[76:79], v[168:171]
    ds_read_b64_tr_b16 v[44:45], v5 offset:40960
    ds_read_b64_tr_b16 v[46:47], v5 offset:45056
    v_cvt_pk_bf16_f32 v182, v188, v189
    v_mfma_f32_16x16x32_bf16 v[172:175], v[48:51], v[80:83], v[20:23]
    v_exp_f32 v190, v190
    v_mfma_f32_16x16x32_bf16 v[172:175], v[52:55], v[84:87], v[172:175]
    ds_read_b64_tr_b16 v[48:49], v2 offset:41984
    ds_read_b64_tr_b16 v[50:51], v2 offset:46080
    v_mfma_f32_16x16x32_bf16 v[172:175], v[56:59], v[88:91], v[172:175]
    v_exp_f32 v191, v191
    v_mfma_f32_16x16x32_bf16 v[172:175], v[60:63], v[92:95], v[172:175]
    v_cvt_pk_bf16_f32 v183, v190, v191
    ds_read_b64_tr_b16 v[52:53], v3 offset:41984
    ds_read_b64_tr_b16 v[54:55], v3 offset:46080
L_seg6:
    s_waitcnt lgkmcnt(4)
    v_smfmac_f32_16x16x64_bf16 v[24:27], v[28:31], v[176:183], v115
    ds_read_b64_tr_b16 v[56:57], v4 offset:41984
    ds_read_b64_tr_b16 v[58:59], v4 offset:46080
    v_mfma_f32_16x16x32_bf16 v[192:195], v[176:179], v[32:35], v[192:195]
    s_setprio 1
    v_exp_f32 v160, v160
    v_mfma_f32_16x16x32_bf16 v[196:199], v[180:183], v[32:35], v[196:199]
    ds_read_b64_tr_b16 v[60:61], v5 offset:41984
    ds_read_b64_tr_b16 v[62:63], v5 offset:46080
    v_mfma_f32_16x16x32_bf16 v[200:203], v[176:179], v[36:39], v[200:203]
    v_exp_f32 v161, v161
    v_mfma_f32_16x16x32_bf16 v[204:207], v[180:183], v[36:39], v[204:207]
    ds_read_b128 v[32:35], v1 offset:57344
    v_cvt_pk_bf16_f32 v160, v160, v161
    v_mfma_f32_16x16x32_bf16 v[208:211], v[176:179], v[40:43], v[208:211]
    v_exp_f32 v162, v162
    v_mfma_f32_16x16x32_bf16 v[212:215], v[180:183], v[40:43], v[212:215]
    ds_read_b128 v[36:39], v1 offset:57856
    buffer_store_dwordx4 v[152:155], v7, s[20:23], s39 offen offset:512 sc1
    v_mfma_f32_16x16x32_bf16 v[216:219], v[176:179], v[44:47], v[216:219]
    v_exp_f32 v163, v163
    v_mfma_f32_16x16x32_bf16 v[220:223], v[180:183], v[44:47], v[220:223]
    ds_read_b128 v[40:43], v1 offset:61440
    s_waitcnt lgkmcnt(3)
    v_mfma_f32_16x16x32_bf16 v[224:227], v[176:179], v[48:51], v[224:227]
    v_exp_f32 v164, v164
    v_mfma_f32_16x16x32_bf16 v[228:231], v[180:183], v[48:51], v[228:231]
    ds_read_b128 v[44:47], v1 offset:61952
    v_cvt_pk_bf16_f32 v161, v162, v163
    v_mfma_f32_16x16x32_bf16 v[232:235], v[176:179], v[52:55], v[232:235]
    v_exp_f32 v165, v165
    v_mfma_f32_16x16x32_bf16 v[236:239], v[180:183], v[52:55], v[236:239]
    ds_read_b128 v[48:51], v1 offset:59392
    v_cvt_pk_bf16_f32 v164, v164, v165
    v_mfma_f32_16x16x32_bf16 v[240:243], v[176:179], v[56:59], v[240:243]
    s_add_u32 s31, s31, 0x8000
    v_exp_f32 v166, v166
    v_mfma_f32_16x16x32_bf16 v[244:247], v[180:183], v[56:59], v[244:247]
    ds_read_b128 v[52:55], v1 offset:59904
    v_mfma_f32_16x16x32_bf16 v[248:251], v[176:179], v[60:63], v[248:251]
    s_cmp_ge_u32 s30, s38
    s_cselect_b32 s10, 0, s10
    v_exp_f32 v167, v167
    v_mfma_f32_16x16x32_bf16 v[252:255], v[180:183], v[60:63], v[252:255]
    ds_read_b128 v[56:59], v1 offset:63488
    s_waitcnt lgkmcnt(3)
    v_mfma_f32_16x16x32_bf16 v[176:179], v[32:35], v[64:67], v[16:19]
    v_exp_f32 v168, v168
    v_mfma_f32_16x16x32_bf16 v[176:179], v[36:39], v[68:71], v[176:179]
    ds_read_b128 v[60:63], v1 offset:64000
    v_cvt_pk_bf16_f32 v165, v166, v167
    v_mfma_f32_16x16x32_bf16 v[176:179], v[40:43], v[72:75], v[176:179]
    v_exp_f32 v169, v169
    v_mfma_f32_16x16x32_bf16 v[176:179], v[44:47], v[76:79], v[176:179]
    buffer_store_dwordx4 v[156:159], v7, s[20:23], s39 offen offset:768 sc1
    v_mfma_f32_16x16x32_bf16 v[180:183], v[32:35], v[80:83], v[20:23]
    v_exp_f32 v170, v170
    v_cvt_pk_bf16_f32 v162, v168, v169
    v_mfma_f32_16x16x32_bf16 v[180:183], v[36:39], v[84:87], v[180:183]
    ds_read_b64_tr_b16 v[32:33], v2 offset:49152
    ds_read_b64_tr_b16 v[34:35], v2 offset:53248
    v_mfma_f32_16x16x32_bf16 v[180:183], v[40:43], v[88:91], v[180:183]
    s_mov_b32 s22, 0x4000000
    v_exp_f32 v171, v171
    v_mfma_f32_16x16x32_bf16 v[180:183], v[44:47], v[92:95], v[180:183]
    ds_read_b64_tr_b16 v[36:37], v3 offset:49152
    ds_read_b64_tr_b16 v[38:39], v3 offset:53248
    s_waitcnt lgkmcnt(4)
    v_mfma_f32_16x16x32_bf16 v[184:187], v[48:51], v[64:67], v[16:19]
    s_lshl_b32 s32, s30, 15
    v_exp_f32 v172, v172
    v_cvt_pk_bf16_f32 v163, v170, v171
    v_mfma_f32_16x16x32_bf16 v[184:187], v[52:55], v[68:71], v[184:187]
    ds_read_b64_tr_b16 v[40:41], v4 offset:49152
    ds_read_b64_tr_b16 v[42:43], v4 offset:53248
    v_mfma_f32_16x16x32_bf16 v[184:187], v[56:59], v[72:75], v[184:187]
    s_add_u32 s32, s32, s36
    v_exp_f32 v173, v173
    v_mfma_f32_16x16x32_bf16 v[184:187], v[60:63], v[76:79], v[184:187]
    ds_read_b64_tr_b16 v[44:45], v5 offset:49152
    ds_read_b64_tr_b16 v[46:47], v5 offset:53248
    v_cvt_pk_bf16_f32 v166, v172, v173
    v_mfma_f32_16x16x32_bf16 v[188:191], v[48:51], v[80:83], v[20:23]
    s_add_u32 s39, s32, 0x1000
    v_exp_f32 v174, v174
    v_mfma_f32_16x16x32_bf16 v[188:191], v[52:55], v[84:87], v[188:191]
    ds_read_b64_tr_b16 v[48:49], v2 offset:50176
    ds_read_b64_tr_b16 v[50:51], v2 offset:54272
    v_mfma_f32_16x16x32_bf16 v[188:191], v[56:59], v[88:91], v[188:191]
    v_exp_f32 v175, v175
    v_mfma_f32_16x16x32_bf16 v[188:191], v[60:63], v[92:95], v[188:191]
    v_cvt_pk_bf16_f32 v167, v174, v175
    ds_read_b64_tr_b16 v[52:53], v3 offset:50176
    ds_read_b64_tr_b16 v[54:55], v3 offset:54272
L_seg7:
    s_waitcnt lgkmcnt(4)
    v_smfmac_f32_16x16x64_bf16 v[24:27], v[28:31], v[160:167], v115
    ds_read_b64_tr_b16 v[56:57], v4 offset:50176
    ds_read_b64_tr_b16 v[58:59], v4 offset:54272
    v_mov_b32 v64, v96
    v_mov_b32 v65, v97
    v_mfma_f32_16x16x32_bf16 v[192:195], v[160:163], v[32:35], v[192:195]
    v_exp_f32 v176, v176
    v_mov_b32 v66, v98
    v_mov_b32 v67, v99
    v_mfma_f32_16x16x32_bf16 v[196:199], v[164:167], v[32:35], v[196:199]
    ds_read_b64_tr_b16 v[60:61], v5 offset:50176
    ds_read_b64_tr_b16 v[62:63], v5 offset:54272
    v_mov_b32 v68, v100
    v_mov_b32 v69, v101
    v_mfma_f32_16x16x32_bf16 v[200:203], v[160:163], v[36:39], v[200:203]
    v_exp_f32 v177, v177
    v_mov_b32 v70, v102
    v_mov_b32 v71, v103
    v_mfma_f32_16x16x32_bf16 v[204:207], v[164:167], v[36:39], v[204:207]
    ds_read_b128 v[32:35], v1
    s_waitcnt vmcnt(6)
    ds_read_b128 v[72:75], v6
    v_mfma_f32_16x16x32_bf16 v[208:211], v[160:163], v[40:43], v[208:211]
    v_exp_f32 v178, v178
    v_cvt_pk_bf16_f32 v176, v176, v177
    v_mfma_f32_16x16x32_bf16 v[212:215], v[164:167], v[40:43], v[212:215]
    ds_read_b128 v[36:39], v1 offset:512
    ds_read_b128 v[88:91], v6 offset:2048
    v_mov_b32 v80, v104
    v_mfma_f32_16x16x32_bf16 v[216:219], v[160:163], v[44:47], v[216:219]
    v_exp_f32 v179, v179
    v_mov_b32 v81, v105
    v_mfma_f32_16x16x32_bf16 v[220:223], v[164:167], v[44:47], v[220:223]
    ds_read_b128 v[76:79], v114
    ds_read_b128 v[92:95], v114 offset:2048
    ds_read_b128 v[40:43], v1 offset:4096
    s_waitcnt lgkmcnt(7)
    v_mfma_f32_16x16x32_bf16 v[224:227], v[160:163], v[48:51], v[224:227]
    v_exp_f32 v180, v180
    v_mov_b32 v82, v106
    v_mfma_f32_16x16x32_bf16 v[228:231], v[164:167], v[48:51], v[228:231]
    ds_read_b128 v[44:47], v1 offset:4608
    v_cvt_pk_bf16_f32 v177, v178, v179
    v_mov_b32 v83, v107
    v_mfma_f32_16x16x32_bf16 v[232:235], v[160:163], v[52:55], v[232:235]
    v_exp_f32 v181, v181
    v_mov_b32 v84, v108
    v_mfma_f32_16x16x32_bf16 v[236:239], v[164:167], v[52:55], v[236:239]
    ds_read_b128 v[48:51], v1 offset:2048
    v_cvt_pk_bf16_f32 v180, v180, v181
    v_mov_b32 v85, v109
    v_mfma_f32_16x16x32_bf16 v[240:243], v[160:163], v[56:59], v[240:243]
    s_add_u32 m0, s47, 0
    v_exp_f32 v182, v182
    v_mov_b32 v86, v110
    v_mfma_f32_16x16x32_bf16 v[244:247], v[164:167], v[56:59], v[244:247]
    s_add_u32 s42, s31, 0
    ds_read_b128 v[52:55], v1 offset:2560
    s_waitcnt lgkmcnt(4)
    buffer_load_dwordx4 v8, s[8:11], s42 offen nt lds
    v_mfma_f32_16x16x32_bf16 v[248:251], v[160:163], v[60:63], v[248:251]
    s_add_u32 m0, s47, 0x400
    v_exp_f32 v183, v183
    v_mov_b32 v87, v111
    v_mfma_f32_16x16x32_bf16 v[252:255], v[164:167], v[60:63], v[252:255]
    s_add_u32 s42, s31, 0x800
    ds_read_b128 v[56:59], v1 offset:6144
    buffer_load_dwordx4 v9, s[8:11], s42 offen nt lds
    s_cmp_eq_u32 s30, s43
    s_cbranch_scc1 L_seg8
    s_waitcnt lgkmcnt(3)
    v_mfma_f32_16x16x32_bf16 v[160:163], v[32:35], v[64:67], 0
    s_add_u32 m0, s47, 0x800
    v_exp_f32 v184, v184
    v_cvt_pk_bf16_f32 v181, v182, v183
    v_mfma_f32_16x16x32_bf16 v[160:163], v[36:39], v[68:71], v[160:163]
    s_add_u32 s42, s31, 0x1000
    ds_read_b128 v[60:63], v1 offset:6656
    buffer_load_dwordx4 v8, s[8:11], s42 offen nt lds
    v_mfma_f32_16x16x32_bf16 v[160:163], v[40:43], v[72:75], v[160:163]
    s_add_u32 m0, s47, 0xc00
    v_exp_f32 v185, v185
    v_mfma_f32_16x16x32_bf16 v[160:163], v[44:47], v[76:79], v[160:163]
    s_add_u32 s42, s31, 0x1800
    buffer_load_dwordx4 v9, s[8:11], s42 offen nt lds
    v_cvt_pk_bf16_f32 v178, v184, v185
    v_mfma_f32_16x16x32_bf16 v[164:167], v[32:35], v[80:83], 0
    v_exp_f32 v186, v186
    v_mfma_f32_16x16x32_bf16 v[164:167], v[36:39], v[84:87], v[164:167]
    ds_read_b64_tr_b16 v[32:33], v2 offset:57344
    ds_read_b64_tr_b16 v[34:35], v2 offset:61440
    v_mfma_f32_16x16x32_bf16 v[164:167], v[40:43], v[88:91], v[164:167]
    v_exp_f32 v187, v187
    v_mfma_f32_16x16x32_bf16 v[164:167], v[44:47], v[92:95], v[164:167]
    ds_read_b64_tr_b16 v[36:37], v3 offset:57344
    ds_read_b64_tr_b16 v[38:39], v3 offset:61440
    s_waitcnt lgkmcnt(4)
    v_mfma_f32_16x16x32_bf16 v[168:171], v[48:51], v[64:67], 0
    v_exp_f32 v188, v188
    v_cvt_pk_bf16_f32 v179, v186, v187
    v_mfma_f32_16x16x32_bf16 v[168:171], v[52:55], v[68:71], v[168:171]
    ds_read_b64_tr_b16 v[40:41], v4 offset:57344
    ds_read_b64_tr_b16 v[42:43], v4 offset:61440
    v_mfma_f32_16x16x32_bf16 v[168:171], v[56:59], v[72:75], v[168:171]
    v_exp_f32 v189, v189
    v_max3_f32 v10, v160, v161, v162
    v_max_f32 v10, v10, v163
    v_max3_f32 v11, v164, v165, v166
    v_max_f32 v11, v11, v167
    v_mfma_f32_16x16x32_bf16 v[168:171], v[60:63], v[76:79], v[168:171]
    ds_read_b64_tr_b16 v[44:45], v5 offset:57344
    ds_read_b64_tr_b16 v[46:47], v5 offset:61440
    v_cvt_pk_bf16_f32 v182, v188, v189
    v_permlane32_swap_b32 v10, v11
    v_max_f32 v10, v10, v11
    v_mov_b32 v11, v10
    v_mfma_f32_16x16x32_bf16 v[172:175], v[48:51], v[80:83], 0
    v_exp_f32 v190, v190
    v_permlane16_swap_b32 v10, v11
    v_max_f32 v10, v10, v11
    v_mov_b32 v11, v10
    v_mfma_f32_16x16x32_bf16 v[172:175], v[52:55], v[84:87], v[172:175]
    ds_read_b64_tr_b16 v[48:49], v2 offset:58368
    ds_read_b64_tr_b16 v[50:51], v2 offset:62464
    v_permlane32_swap_b32 v10, v11
    v_sub_f32 v16, 0, v10
    v_sub_f32 v17, 0, v10
    v_mfma_f32_16x16x32_bf16 v[172:175], v[56:59], v[88:91], v[172:175]
    v_exp_f32 v191, v191
    v_sub_f32 v18, 0, v10
    v_sub_f32 v19, 0, v10
    v_sub_f32 v20, 0, v11
    v_sub_f32 v21, 0, v11
    v_mfma_f32_16x16x32_bf16 v[172:175], v[60:63], v[92:95], v[172:175]
    v_cvt_pk_bf16_f32 v183, v190, v191
    v_sub_f32 v22, 0, v11
    v_sub_f32 v23, 0, v11
    ds_read_b64_tr_b16 v[52:53], v3 offset:58368
    ds_read_b64_tr_b16 v[54:55], v3 offset:62464
    s_add_u32 s30, s30, 1
    s_branch L_seg0
L_seg8:
    ds_read_b64_tr_b16 v[32:33], v2 offset:57344
    ds_read_b64_tr_b16 v[34:35], v2 offset:61440
    ds_read_b64_tr_b16 v[36:37], v3 offset:57344
    ds_read_b64_tr_b16 v[38:39], v3 offset:61440
    s_waitcnt lgkmcnt(8)
    ds_read_b64_tr_b16 v[40:41], v4 offset:57344
    ds_read_b64_tr_b16 v[42:43], v4 offset:61440
    s_waitcnt lgkmcnt(9)
    ds_read_b64_tr_b16 v[44:45], v5 offset:57344
    ds_read_b64_tr_b16 v[46:47], v5 offset:61440
    s_waitcnt lgkmcnt(10)
    ds_read_b64_tr_b16 v[48:49], v2 offset:58368
    ds_read_b64_tr_b16 v[50:51], v2 offset:62464
    s_waitcnt lgkmcnt(11)
    ds_read_b64_tr_b16 v[52:53], v3 offset:58368
    ds_read_b64_tr_b16 v[54:55], v3 offset:62464
    s_waitcnt lgkmcnt(12)
    ds_read_b64_tr_b16 v[56:57], v4 offset:58368
    ds_read_b64_tr_b16 v[58:59], v4 offset:62464
    ds_read_b64_tr_b16 v[60:61], v5 offset:58368
    ds_read_b64_tr_b16 v[62:63], v5 offset:62464
    v_exp_f32 v184, v184
    v_cvt_pk_bf16_f32 v181, v182, v183
    v_exp_f32 v185, v185
    s_nop 0
    v_cvt_pk_bf16_f32 v178, v184, v185
    v_exp_f32 v186, v186
    v_exp_f32 v187, v187
    v_exp_f32 v188, v188
    v_cvt_pk_bf16_f32 v179, v186, v187
    v_exp_f32 v189, v189
    s_nop 0
    v_cvt_pk_bf16_f32 v182, v188, v189
    v_exp_f32 v190, v190
    v_exp_f32 v191, v191
    s_nop 0
    v_cvt_pk_bf16_f32 v183, v190, v191
    s_nop 1
    v_smfmac_f32_16x16x64_bf16 v[24:27], v[28:31], v[176:183], v115
    s_waitcnt lgkmcnt(14)
    v_mfma_f32_16x16x32_bf16 v[192:195], v[176:179], v[32:35], v[192:195]
    s_waitcnt lgkmcnt(12)
    v_mfma_f32_16x16x32_bf16 v[200:203], v[176:179], v[36:39], v[200:203]
    s_waitcnt lgkmcnt(10)
    v_mfma_f32_16x16x32_bf16 v[208:211], v[176:179], v[40:43], v[208:211]
    s_waitcnt lgkmcnt(8)
    v_mfma_f32_16x16x32_bf16 v[216:219], v[176:179], v[44:47], v[216:219]
    v_add_f32 v10, v24, v25
    v_add_f32 v11, v26, v27
    s_waitcnt lgkmcnt(6)
    v_mfma_f32_16x16x32_bf16 v[224:227], v[176:179], v[48:51], v[224:227]
    v_max_f32 v0, v10, v11
    v_cmp_nge_f32_e64 s[48:49], s29, v0
    v_rcp_f32 v10, v10
    s_waitcnt lgkmcnt(4)
    v_mfma_f32_16x16x32_bf16 v[232:235], v[176:179], v[52:55], v[232:235]
    v_rcp_f32 v11, v11
    v_cvt_pk_bf16_f32 v0, v10, v10
    v_and_b32 v0, 0xffff0000, v0
    s_waitcnt lgkmcnt(2)
    v_mfma_f32_16x16x32_bf16 v[240:243], v[176:179], v[56:59], v[240:243]
    v_sub_f32 v0, v10, v0
    v_cvt_pk_bf16_f32 v124, v10, v0
    s_waitcnt lgkmcnt(0)
    v_mfma_f32_16x16x32_bf16 v[248:251], v[176:179], v[60:63], v[248:251]
    v_mfma_f32_16x16x32_bf16 v[116:119], v[124:127], v[12:15], 0
    v_cvt_pk_bf16_f32 v0, v11, v11
    v_and_b32 v0, 0xffff0000, v0
    v_mfma_f32_16x16x32_bf16 v[196:199], v[180:183], v[32:35], v[196:199]
    v_sub_f32 v0, v11, v0
    v_cvt_pk_bf16_f32 v124, v11, v0
    v_mfma_f32_16x16x32_bf16 v[204:207], v[180:183], v[36:39], v[204:207]
    s_nop 0
    v_mfma_f32_16x16x32_bf16 v[120:123], v[124:127], v[12:15], 0
    v_mfma_f32_16x16x32_bf16 v[212:215], v[180:183], v[40:43], v[212:215]
    v_mul_f32 v192, v192, v116
    v_mul_f32 v200, v200, v116
    v_mul_f32 v208, v208, v116
    v_mul_f32 v216, v216, v116
    v_mfma_f32_16x16x32_bf16 v[220:223], v[180:183], v[44:47], v[220:223]
    v_mul_f32 v224, v224, v116
    v_mul_f32 v232, v232, v116
    v_mul_f32 v240, v240, v116
    v_mul_f32 v248, v248, v116
    v_mfma_f32_16x16x32_bf16 v[228:231], v[180:183], v[48:51], v[228:231]
    v_cvt_pk_bf16_f32 v128, v192, v200
    v_cvt_pk_bf16_f32 v129, v208, v216
    v_cvt_pk_bf16_f32 v130, v224, v232
    v_cvt_pk_bf16_f32 v131, v240, v248
    v_mfma_f32_16x16x32_bf16 v[236:239], v[180:183], v[52:55], v[236:239]
    buffer_store_dwordx4 v[128:131], v7, s[20:23], s32 offen sc1
    v_mul_f32 v193, v193, v117
    v_mul_f32 v201, v201, v117
    v_mul_f32 v209, v209, v117
    v_mfma_f32_16x16x32_bf16 v[244:247], v[180:183], v[56:59], v[244:247]
    v_mul_f32 v217, v217, v117
    v_mul_f32 v225, v225, v117
    v_mul_f32 v233, v233, v117
    v_mul_f32 v241, v241, v117
    v_mfma_f32_16x16x32_bf16 v[252:255], v[180:183], v[60:63], v[252:255]
    v_mul_f32 v249, v249, v117
    v_cvt_pk_bf16_f32 v132, v193, v201
    v_cvt_pk_bf16_f32 v133, v209, v217
    v_cvt_pk_bf16_f32 v134, v225, v233
    v_cvt_pk_bf16_f32 v135, v241, v249
    buffer_store_dwordx4 v[132:135], v7, s[20:23], s32 offen offset:256 sc1
    v_mul_f32 v194, v194, v118
    v_mul_f32 v202, v202, v118
    v_mul_f32 v210, v210, v118
    v_mul_f32 v218, v218, v118
    v_mul_f32 v226, v226, v118
    v_mul_f32 v234, v234, v118
    v_mul_f32 v242, v242, v118
    v_mul_f32 v250, v250, v118
    v_cvt_pk_bf16_f32 v136, v194, v202
    v_cvt_pk_bf16_f32 v137, v210, v218
    v_cvt_pk_bf16_f32 v138, v226, v234
    v_cvt_pk_bf16_f32 v139, v242, v250
    buffer_store_dwordx4 v[136:139], v7, s[20:23], s32 offen offset:512 sc1
    v_mul_f32 v195, v195, v119
    v_mul_f32 v203, v203, v119
    v_mul_f32 v211, v211, v119
    v_mul_f32 v219, v219, v119
    v_mul_f32 v227, v227, v119
    v_mul_f32 v235, v235, v119
    v_mul_f32 v243, v243, v119
    v_mul_f32 v251, v251, v119
    v_cvt_pk_bf16_f32 v140, v195, v203
    v_cvt_pk_bf16_f32 v141, v211, v219
    v_cvt_pk_bf16_f32 v142, v227, v235
    v_cvt_pk_bf16_f32 v143, v243, v251
    buffer_store_dwordx4 v[140:143], v7, s[20:23], s32 offen offset:768 sc1
    v_mul_f32 v196, v196, v120
    v_mul_f32 v204, v204, v120
    v_mul_f32 v212, v212, v120
    v_mul_f32 v220, v220, v120
    v_mul_f32 v228, v228, v120
    v_mul_f32 v236, v236, v120
    v_mul_f32 v244, v244, v120
    v_mul_f32 v252, v252, v120
    v_cvt_pk_bf16_f32 v144, v196, v204
    v_cvt_pk_bf16_f32 v145, v212, v220
    v_cvt_pk_bf16_f32 v146, v228, v236
    v_cvt_pk_bf16_f32 v147, v244, v252
    buffer_store_dwordx4 v[144:147], v7, s[20:23], s39 offen sc1
    v_mul_f32 v197, v197, v121
    v_mul_f32 v205, v205, v121
    v_mul_f32 v213, v213, v121
    v_mul_f32 v221, v221, v121
    v_mul_f32 v229, v229, v121
    v_mul_f32 v237, v237, v121
    v_mul_f32 v245, v245, v121
    v_mul_f32 v253, v253, v121
    v_cvt_pk_bf16_f32 v148, v197, v205
    v_cvt_pk_bf16_f32 v149, v213, v221
    v_cvt_pk_bf16_f32 v150, v229, v237
    v_cvt_pk_bf16_f32 v151, v245, v253
    buffer_store_dwordx4 v[148:151], v7, s[20:23], s39 offen offset:256 sc1
    v_mul_f32 v198, v198, v122
    v_mul_f32 v206, v206, v122
    v_mul_f32 v214, v214, v122
    v_mul_f32 v222, v222, v122
    v_mul_f32 v230, v230, v122
    v_mul_f32 v238, v238, v122
    v_mul_f32 v246, v246, v122
    v_mul_f32 v254, v254, v122
    v_cvt_pk_bf16_f32 v152, v198, v206
    v_cvt_pk_bf16_f32 v153, v214, v222
    v_cvt_pk_bf16_f32 v154, v230, v238
    v_cvt_pk_bf16_f32 v155, v246, v254
    buffer_store_dwordx4 v[152:155], v7, s[20:23], s39 offen offset:512 sc1
    v_mul_f32 v199, v199, v123
    v_mul_f32 v207, v207, v123
    v_mul_f32 v215, v215, v123
    v_mul_f32 v223, v223, v123
    v_mul_f32 v231, v231, v123
    v_mul_f32 v239, v239, v123
    v_mul_f32 v247, v247, v123
    v_mul_f32 v255, v255, v123
    v_cvt_pk_bf16_f32 v156, v199, v207
    v_cvt_pk_bf16_f32 v157, v215, v223
    v_cvt_pk_bf16_f32 v158, v231, v239
    v_cvt_pk_bf16_f32 v159, v247, v255
    buffer_store_dwordx4 v[156:159], v7, s[20:23], s39 offen offset:768 sc1
    s_cmp_lg_u64 s[48:49], 0
    s_addc_u32 s33, s33, s33
    s_lshl_b32 s41, 1, s43
    s_lshl_b32 s40, s41, 1
    s_sub_u32 s40, s40, 1
    s_and_b32 s33, s33, s40
    s_cbranch_scc1 L_slow
L_end:
    s_endpgm
L_sync0:
    s_barrier
    s_branch L_back0
L_sync1:
    s_barrier
    s_mov_b64 vcc, 0
    s_branch L_back1
L_kscale:
    ds_read_b128 v[192:195], v24
    ds_read_b128 v[196:199], v24 offset:512
    ds_read_b128 v[200:203], v24 offset:4096
    ds_read_b128 v[204:207], v24 offset:4608
    s_waitcnt lgkmcnt(3)
    v_mfma_f32_16x16x32_bf16 v[224:227], v[240:243], v[192:195], 0
    s_waitcnt lgkmcnt(2)
    v_mfma_f32_16x16x32_bf16 v[228:231], v[240:243], v[196:199], 0
    s_waitcnt lgkmcnt(1)
    v_mfma_f32_16x16x32_bf16 v[232:235], v[240:243], v[200:203], 0
    s_waitcnt lgkmcnt(0)
    v_mfma_f32_16x16x32_bf16 v[236:239], v[240:243], v[204:207], 0
    v_add_u32 v24, 0x2000, v24
    s_nop 0
    v_cvt_pk_bf16_f32 v192, v224, v225
    v_cvt_pk_bf16_f32 v193, v226, v227
    ds_write_b64 v244, v[192:193]
    v_cvt_pk_bf16_f32 v194, v228, v229
    v_cvt_pk_bf16_f32 v195, v230, v231
    ds_write_b64 v244, v[194:195] offset:512
    v_cvt_pk_bf16_f32 v196, v232, v233
    v_cvt_pk_bf16_f32 v197, v234, v235
    ds_write_b64 v244, v[196:197] offset:4096
    v_cvt_pk_bf16_f32 v198, v236, v237
    v_cvt_pk_bf16_f32 v199, v238, v239
    ds_write_b64 v244, v[198:199] offset:4608
    v_add_u32 v244, 0x2000, v244
    s_setpc_b64 s[52:53]
L_vrelay:
    ds_read_b64_tr_b16 v[208:209], v25
    ds_read_b64_tr_b16 v[210:211], v25 offset:512
    ds_read_b64_tr_b16 v[212:213], v25 offset:1024
    ds_read_b64_tr_b16 v[214:215], v25 offset:1536
    s_waitcnt lgkmcnt(0)
    ds_write_b64 v26, v[208:209]
    ds_write_b64 v27, v[210:211]
    ds_write_b64 v26, v[212:213] offset:128
    ds_write_b64 v27, v[214:215] offset:128
    v_add_u32 v25, 0x2000, v25
    v_add_u32 v26, 0x2000, v26
    v_add_u32 v27, 0x2000, v27
    s_setpc_b64 s[52:53]
L_kv:
    ds_read_b128 v[192:195], v24
    ds_read_b128 v[196:199], v24 offset:512
    ds_read_b128 v[200:203], v24 offset:4096
    ds_read_b128 v[204:207], v24 offset:4608
    ds_read_b64_tr_b16 v[208:209], v25
    ds_read_b64_tr_b16 v[210:211], v25 offset:512
    ds_read_b64_tr_b16 v[212:213], v25 offset:1024
    ds_read_b64_tr_b16 v[214:215], v25 offset:1536
    s_waitcnt lgkmcnt(7)
    v_mfma_f32_16x16x32_bf16 v[224:227], v[240:243], v[192:195], 0
    s_waitcnt lgkmcnt(6)
    v_mfma_f32_16x16x32_bf16 v[228:231], v[240:243], v[196:199], 0
    s_waitcnt lgkmcnt(5)
    v_mfma_f32_16x16x32_bf16 v[232:235], v[240:243], v[200:203], 0
    s_waitcnt lgkmcnt(4)
    v_mfma_f32_16x16x32_bf16 v[236:239], v[240:243], v[204:207], 0
    v_add_u32 v24, 0x2000, v24
    s_waitcnt lgkmcnt(0)
    ds_write_b64 v26, v[208:209]
    ds_write_b64 v27, v[210:211]
    ds_write_b64 v26, v[212:213] offset:128
    ds_write_b64 v27, v[214:215] offset:128
    v_add_u32 v25, 0x2000, v25
    v_add_u32 v26, 0x2000, v26
    v_add_u32 v27, 0x2000, v27
    v_cvt_pk_bf16_f32 v192, v224, v225
    v_cvt_pk_bf16_f32 v193, v226, v227
    ds_write_b64 v244, v[192:193]
    v_cvt_pk_bf16_f32 v194, v228, v229
    v_cvt_pk_bf16_f32 v195, v230, v231
    ds_write_b64 v244, v[194:195] offset:512
    v_cvt_pk_bf16_f32 v196, v232, v233
    v_cvt_pk_bf16_f32 v197, v234, v235
    ds_write_b64 v244, v[196:197] offset:4096
    v_cvt_pk_bf16_f32 v198, v236, v237
    v_cvt_pk_bf16_f32 v199, v238, v239
    ds_write_b64 v244, v[198:199] offset:4608
    v_add_u32 v244, 0x2000, v244
    s_setpc_b64 s[52:53]
L_kv2:
    ds_read_b128 v[192:195], v24
    ds_read_b128 v[196:199], v24 offset:512
    ds_read_b128 v[200:203], v24 offset:4096
    ds_read_b128 v[204:207], v24 offset:4608
    ds_read_b128 v[64:67], v24 offset:8192
    ds_read_b128 v[68:71], v24 offset:8704
    ds_read_b128 v[72:75], v24 offset:12288
    ds_read_b128 v[76:79], v24 offset:12800
    ds_read_b64_tr_b16 v[208:209], v25
    ds_read_b64_tr_b16 v[210:211], v25 offset:512
    ds_read_b64_tr_b16 v[212:213], v25 offset:1024
    ds_read_b64_tr_b16 v[214:215], v25 offset:1536
    ds_read_b64_tr_b16 v[32:33], v25 offset:8192
    ds_read_b64_tr_b16 v[34:35], v25 offset:8704
    ds_read_b64_tr_b16 v[36:37], v25 offset:9216
    ds_read_b64_tr_b16 v[38:39], v25 offset:9728
    s_waitcnt lgkmcnt(15)
    v_mfma_f32_16x16x32_bf16 v[224:227], v[240:243], v[192:195], 0
    s_waitcnt lgkmcnt(14)
    v_mfma_f32_16x16x32_bf16 v[228:231], v[240:243], v[196:199], 0
    s_waitcnt lgkmcnt(13)
    v_mfma_f32_16x16x32_bf16 v[232:235], v[240:243], v[200:203], 0
    s_waitcnt lgkmcnt(12)
    v_mfma_f32_16x16x32_bf16 v[236:239], v[240:243], v[204:207], 0
    s_waitcnt lgkmcnt(11)
    v_mfma_f32_16x16x32_bf16 v[80:83], v[240:243], v[64:67], 0
    s_waitcnt lgkmcnt(10)
    v_mfma_f32_16x16x32_bf16 v[84:87], v[240:243], v[68:71], 0
    s_waitcnt lgkmcnt(9)
    v_mfma_f32_16x16x32_bf16 v[88:91], v[240:243], v[72:75], 0
    s_waitcnt lgkmcnt(8)
    v_mfma_f32_16x16x32_bf16 v[92:95], v[240:243], v[76:79], 0
    s_waitcnt lgkmcnt(4)
    ds_write_b64 v26, v[208:209]
    ds_write_b64 v27, v[210:211]
    ds_write_b64 v26, v[212:213] offset:128
    ds_write_b64 v27, v[214:215] offset:128
    s_waitcnt lgkmcnt(4)
    ds_write_b64 v26, v[32:33] offset:8192
    ds_write_b64 v27, v[34:35] offset:8192
    ds_write_b64 v26, v[36:37] offset:8320
    ds_write_b64 v27, v[38:39] offset:8320
    v_cvt_pk_bf16_f32 v192, v224, v225
    v_cvt_pk_bf16_f32 v193, v226, v227
    ds_write_b64 v244, v[192:193]
    v_cvt_pk_bf16_f32 v194, v228, v229
    v_cvt_pk_bf16_f32 v195, v230, v231
    ds_write_b64 v244, v[194:195] offset:512
    v_cvt_pk_bf16_f32 v196, v232, v233
    v_cvt_pk_bf16_f32 v197, v234, v235
    ds_write_b64 v244, v[196:197] offset:4096
    v_cvt_pk_bf16_f32 v198, v236, v237
    v_cvt_pk_bf16_f32 v199, v238, v239
    ds_write_b64 v244, v[198:199] offset:4608
    v_cvt_pk_bf16_f32 v64, v80, v81
    v_cvt_pk_bf16_f32 v65, v82, v83
    ds_write_b64 v244, v[64:65] offset:8192
    v_cvt_pk_bf16_f32 v66, v84, v85
    v_cvt_pk_bf16_f32 v67, v86, v87
    ds_write_b64 v244, v[66:67] offset:8704
    v_cvt_pk_bf16_f32 v68, v88, v89
    v_cvt_pk_bf16_f32 v69, v90, v91
    ds_write_b64 v244, v[68:69] offset:12288
    v_cvt_pk_bf16_f32 v70, v92, v93
    v_cvt_pk_bf16_f32 v71, v94, v95
    ds_write_b64 v244, v[70:71] offset:12800
    v_add_u32 v24, 0x4000, v24
    v_add_u32 v244, 0x4000, v244
    v_add_u32 v25, 0x4000, v25
    v_add_u32 v26, 0x4000, v26
    v_add_u32 v27, 0x4000, v27
    s_setpc_b64 s[52:53]
L_groupB:
    s_setprio 3
    s_add_u32 s36, s36, 0x28000
    s_add_u32 m0, s41, 0x4000
    s_add_u32 s42, s37, 0x4000
    buffer_load_dwordx4 v124, s[12:15], s42 offen lds
    s_add_u32 m0, s41, 0x5000
    s_add_u32 s42, s37, 0x4080
    buffer_load_dwordx4 v124, s[12:15], s42 offen lds
    s_mov_b32 s35, s45
    s_mov_b32 s16, s24
    s_and_b32 s17, s25, 0xffff
    s_mov_b32 s18, 0x800000
    s_mov_b32 s19, 0x20000
    s_add_u32 m0, s45, 0
    s_add_u32 s42, s44, 0
    buffer_load_dwordx4 v125, s[16:19], s42 offen lds
    s_add_u32 m0, s45, 0x400
    s_add_u32 s42, s44, 0x400
    buffer_load_dwordx4 v125, s[16:19], s42 offen lds
    s_add_u32 m0, s41, 0x6000
    s_add_u32 s42, s37, 0x6000
    buffer_load_dwordx4 v124, s[12:15], s42 offen lds
    s_add_u32 m0, s41, 0x7000
    s_add_u32 s42, s37, 0x6080
    buffer_load_dwordx4 v124, s[12:15], s42 offen lds
    s_add_u32 m0, s45, 0x2000
    s_add_u32 s42, s44, 0x2000
    buffer_load_dwordx4 v125, s[16:19], s42 offen lds
    s_add_u32 m0, s45, 0x2400
    s_add_u32 s42, s44, 0x2400
    buffer_load_dwordx4 v125, s[16:19], s42 offen lds
    s_mov_b32 s8, s4
    s_and_b32 s9, s5, 0xffff
    s_mov_b32 s10, 0x4000000
    s_mov_b32 s11, 0x20000
    s_mov_b32 s6, s35
    s_mov_b32 s7, s43
    s_mov_b32 s28, s39
    s_mov_b64 vcc, 0
    s_mov_b32 s20, s26
    s_and_b32 s21, s27, 0xffff
    s_mov_b32 s22, 0
    s_mov_b32 s23, 0x20000
    s_mov_b32 s29, 0x4f800000
    s_lshl_b32 s35, s34, 12
    s_add_u32 s35, s35, 0x20000
    s_mov_b32 s47, s35
    v_xor_b32 v162, v161, v163
    v_lshlrev_b32 v8, 8, v160
    v_lshl_add_u32 v8, v162, 4, v8
    v_xor_b32 v9, 64, v8
    v_lshlrev_b32 v162, 1, v160
    v_and_b32 v162, 7, v162
    v_xor_b32 v162, v162, v161
    v_lshlrev_b32 v112, 9, v160
    v_lshl_add_u32 v112, v162, 4, v112
    v_add_u32 v112, s35, v112
    v_and_b32 v160, 15, v166
    v_bfe_u32 v162, v166, 1, 3
    v_lshlrev_b32 v6, 7, v160
    v_add_u32 v6, s35, v6
    v_lshlrev_b32 v7, 10, v163
    v_lshl_add_u32 v7, v160, 4, v7
    v_and_b32 v161, 1, v163
    v_xor_b32 v162, v162, v163
    v_lshl_add_u32 v6, v162, 4, v6
    v_xor_b32 v114, 64, v6
    v_mov_b32 v12, 0x3f803f80
    v_mov_b32 v13, 0x3f803f80
    v_mov_b32 v14, 0x3f803f80
    v_mov_b32 v15, 0x3f803f80
    v_lshrrev_b32 v162, 4, v166
    v_xor_b32 v162, v162, v166
    v_and_b32 v162, 2, v162
    v_lshrrev_b32 v162, 1, v162
    v_add_u32 v162, -1, v162
    v_and_b32 v28, 0x40804080, v162
    v_and_b32 v29, 0x40804080, v162
    v_and_b32 v30, 0x40804080, v162
    v_and_b32 v31, 0x40804080, v162
    v_and_b32 v162, 1, v166
    v_mul_u32_u24 v162, 0xaaaa, v162
    v_add_u32 v115, 0x4444, v162
    v_lshrrev_b32 v162, 3, v160
    v_lshlrev_b32 v1, 10, v162
    v_and_b32 v162, 7, v166
    v_lshl_add_u32 v1, v162, 4, v1
    v_lshl_add_u32 v1, v163, 7, v1
    v_bfe_u32 v162, v166, 2, 2
    v_mul_u32_u24 v2, 0x120, v162
    v_lshl_add_u32 v2, v161, 7, v2
    v_lshrrev_b32 v162, 5, v166
    v_lshl_add_u32 v2, v162, 11, v2
    v_and_b32 v162, 3, v166
    v_lshl_add_u32 v2, v162, 3, v2
    v_add_u32 v2, 0x10000, v2
    v_xor_b32 v3, 32, v2
    v_xor_b32 v4, 64, v2
    v_xor_b32 v5, 0x60, v2
    s_add_u32 s31, s36, 0x8000
    s_mov_b32 s32, s36
    s_mov_b32 s39, s36
    s_mov_b32 s30, 0
    s_mov_b32 s33, 0
    v_mbcnt_lo_u32_b32 v166, -1, 0
    v_mbcnt_hi_u32_b32 v166, -1, v166
    v_lshrrev_b32 v160, 3, v166
    v_and_b32 v161, 7, v166
    v_lshrrev_b32 v163, 4, v166
    s_mov_b32 s35, s6
    s_mov_b32 s43, s7
    v_lshl_add_u32 v24, v161, 4, s43
    v_and_b32 v162, 1, v160
    v_lshl_add_u32 v24, v162, 8, v24
    v_lshrrev_b32 v0, 5, v166
    v_lshl_add_u32 v244, v0, 7, v24
    v_and_b32 v240, 1, v163
    v_lshl_add_u32 v244, v240, 3, v244
    v_lshl_add_u32 v24, v240, 7, v24
    v_xor_b32 v162, v162, v240
    v_add_u32 v162, -1, v162
    v_mul_u32_u24 v0, 0x87db, v0
    v_xor_b32 v0, 0x3e03, v0
    v_and_b32 v0, v0, v162
    v_and_b32 v162, 1, v166
    v_lshlrev_b32 v162, 4, v162
    v_lshlrev_b32 v0, v162, v0
    v_bfe_u32 v162, v166, 1, 2
    v_cmp_eq_u32_e64 s[48:49], 0, v162
    s_nop 1
    v_cndmask_b32_e64 v240, 0, v0, s[48:49]
    v_cmp_eq_u32_e64 s[48:49], 1, v162
    s_nop 1
    v_cndmask_b32_e64 v241, 0, v0, s[48:49]
    v_cmp_eq_u32_e64 s[48:49], 2, v162
    s_nop 1
    v_cndmask_b32_e64 v242, 0, v0, s[48:49]
    v_cmp_eq_u32_e64 s[48:49], 3, v162
    s_nop 1
    v_cndmask_b32_e64 v243, 0, v0, s[48:49]
    s_add_u32 s54, s38, L_kscale-L_pc
    s_addc_u32 s55, s28, 0
    s_add_u32 s50, s38, L_vrelay-L_pc
    s_addc_u32 s51, s28, 0
    s_add_u32 s100, s38, L_kv-L_pc
    s_addc_u32 s101, s28, 0
    v_and_b32 v0, 3, v166
    v_lshl_add_u32 v25, v0, 6, s35
    v_bfe_u32 v162, v166, 2, 2
    v_lshl_add_u32 v25, v162, 4, v25
    v_lshl_add_u32 v26, v162, 3, s35
    v_and_b32 v162, 1, v163
    v_lshl_add_u32 v25, v162, 3, v25
    v_lshl_add_u32 v26, v162, 10, v26
    v_lshrrev_b32 v162, 5, v166
    v_lshl_add_u32 v25, v162, 8, v25
    v_lshl_add_u32 v26, v162, 8, v26
    v_xor_b32 v162, v162, v0
    v_lshl_add_u32 v26, v162, 5, v26
    v_xor_b32 v27, 64, v26
    v_add_u32 v27, 0x200, v27
    s_mov_b32 s43, 2
    s_mov_b32 s38, 1
    s_add_u32 s26, s54, L_kv2-L_kscale
    s_addc_u32 s27, s55, 0
    s_waitcnt vmcnt(10)
    s_swappc_b64 s[52:53], s[54:55]
    s_waitcnt vmcnt(8)
    s_swappc_b64 s[52:53], s[54:55]
    s_waitcnt lgkmcnt(0)
    s_barrier
    s_add_u32 m0, s41, 0x8000
    s_add_u32 s42, s37, 0x8000
    buffer_load_dwordx4 v124, s[12:15], s42 offen lds
    s_add_u32 m0, s41, 0x9000
    s_add_u32 s42, s37, 0x8080
    buffer_load_dwordx4 v124, s[12:15], s42 offen lds
    s_add_u32 m0, s45, 0x4000
    s_add_u32 s42, s44, 0x4000
    buffer_load_dwordx4 v125, s[16:19], s42 offen lds
    s_add_u32 m0, s45, 0x4400
    s_add_u32 s42, s44, 0x4400
    buffer_load_dwordx4 v125, s[16:19], s42 offen lds
    s_waitcnt vmcnt(8)
    s_swappc_b64 s[52:53], s[100:101]
    s_waitcnt lgkmcnt(0)
    s_barrier
    s_add_u32 m0, s41, 0xa000
    s_add_u32 s42, s37, 0xa000
    buffer_load_dwordx4 v124, s[12:15], s42 offen lds
    s_add_u32 m0, s41, 0xb000
    s_add_u32 s42, s37, 0xa080
    buffer_load_dwordx4 v124, s[12:15], s42 offen lds
    s_add_u32 m0, s45, 0x6000
    s_add_u32 s42, s44, 0x6000
    buffer_load_dwordx4 v125, s[16:19], s42 offen lds
    s_add_u32 m0, s45, 0x6400
    s_add_u32 s42, s44, 0x6400
    buffer_load_dwordx4 v125, s[16:19], s42 offen lds
    s_add_u32 m0, s41, 0xc000
    s_add_u32 s42, s37, 0xc000
    buffer_load_dwordx4 v124, s[12:15], s42 offen lds
    s_add_u32 m0, s41, 0xd000
    s_add_u32 s42, s37, 0xc080
    buffer_load_dwordx4 v124, s[12:15], s42 offen lds
    s_add_u32 m0, s45, 0x8000
    s_add_u32 s42, s44, 0x8000
    buffer_load_dwordx4 v125, s[16:19], s42 offen lds
    s_add_u32 m0, s45, 0x8400
    s_add_u32 s42, s44, 0x8400
    buffer_load_dwordx4 v125, s[16:19], s42 offen lds
    s_waitcnt vmcnt(8)
    s_swappc_b64 s[52:53], s[26:27]
    s_waitcnt lgkmcnt(0)
    s_barrier
    s_add_u32 m0, s41, 0xe000
    s_add_u32 s42, s37, 0xe000
    buffer_load_dwordx4 v124, s[12:15], s42 offen lds
    s_add_u32 m0, s41, 0xf000
    s_add_u32 s42, s37, 0xe080
    buffer_load_dwordx4 v124, s[12:15], s42 offen lds
    s_add_u32 m0, s45, 0xa000
    s_add_u32 s42, s44, 0xa000
    buffer_load_dwordx4 v125, s[16:19], s42 offen lds
    s_add_u32 m0, s45, 0xa400
    s_add_u32 s42, s44, 0xa400
    buffer_load_dwordx4 v125, s[16:19], s42 offen lds
    s_add_u32 m0, s45, 0xc000
    s_add_u32 s42, s44, 0xc000
    buffer_load_dwordx4 v125, s[16:19], s42 offen lds
    s_add_u32 m0, s45, 0xc400
    s_add_u32 s42, s44, 0xc400
    buffer_load_dwordx4 v125, s[16:19], s42 offen lds
    s_add_u32 m0, s45, 0xe000
    s_add_u32 s42, s44, 0xe000
    buffer_load_dwordx4 v125, s[16:19], s42 offen lds
    s_add_u32 m0, s45, 0xe400
    s_add_u32 s42, s44, 0xe400
    buffer_load_dwordx4 v125, s[16:19], s42 offen lds
    s_waitcnt vmcnt(8)
    s_swappc_b64 s[52:53], s[26:27]
    s_waitcnt lgkmcnt(0)
    s_barrier
    buffer_load_dwordx4 v[128:131], v113, s[8:11], s36 offen nt
    buffer_load_dwordx4 v[132:135], v113, s[8:11], s36 offen offset:256 nt
    buffer_load_dwordx4 v[136:139], v113, s[8:11], s36 offen offset:512 nt
    buffer_load_dwordx4 v[140:143], v113, s[8:11], s36 offen offset:768 nt
    buffer_load_dwordx4 v[144:147], v113, s[8:11], s36 offen offset:128 nt
    buffer_load_dwordx4 v[148:151], v113, s[8:11], s36 offen offset:384 nt
    buffer_load_dwordx4 v[152:155], v113, s[8:11], s36 offen offset:640 nt
    buffer_load_dwordx4 v[156:159], v113, s[8:11], s36 offen offset:896 nt
    s_waitcnt vmcnt(12)
    s_swappc_b64 s[52:53], s[100:101]
    s_waitcnt vmcnt(10)
    s_swappc_b64 s[52:53], s[50:51]
    s_waitcnt vmcnt(8)
    s_swappc_b64 s[52:53], s[50:51]
    s_waitcnt lgkmcnt(0)
    s_barrier
    s_waitcnt vmcnt(7)
    ds_write_b128 v112, v[128:131]
    s_waitcnt vmcnt(6)
    ds_write_b128 v112, v[132:135] offset:128
    v_xor_b32 v0, 16, v112
    s_waitcnt vmcnt(5)
    ds_write_b128 v0, v[136:139] offset:256
    s_waitcnt vmcnt(4)
    ds_write_b128 v0, v[140:143] offset:384
    ds_read_b128 v[64:67], v6
    ds_read_b128 v[80:83], v6 offset:2048
    ds_read_b128 v[68:71], v114
    ds_read_b128 v[84:87], v114 offset:2048
    s_waitcnt vmcnt(3)
    ds_write_b128 v112, v[144:147]
    s_waitcnt vmcnt(2)
    ds_write_b128 v112, v[148:151] offset:128
    v_xor_b32 v0, 16, v112
    s_waitcnt vmcnt(1)
    ds_write_b128 v0, v[152:155] offset:256
    s_waitcnt vmcnt(0)
    ds_write_b128 v0, v[156:159] offset:384
    ds_read_b128 v[72:75], v6
    ds_read_b128 v[88:91], v6 offset:2048
    ds_read_b128 v[76:79], v114
    ds_read_b128 v[92:95], v114 offset:2048
    s_setprio 0
    s_branch L_start
L_slow:
    s_waitcnt vmcnt(0) lgkmcnt(0)
    s_mov_b32 s10, 0x4000000
    v_mbcnt_lo_u32_b32 v128, -1, 0
    v_mbcnt_hi_u32_b32 v128, -1, v128
    v_lshrrev_b32 v0, 4, v128
    v_and_b32 v128, 15, v128
    v_lshlrev_b32 v128, 8, v128
    v_lshl_add_u32 v128, v0, 4, v128
    s_mov_b32 s40, s36
L_slow_tile:
    s_and_b32 s42, s33, s41
    s_cbranch_scc0 L_slow_next
    s_add_u32 s39, s40, 0x1000
    buffer_load_dwordx4 v[64:67], v128, s[8:11], s40 offen
    buffer_load_dwordx4 v[68:71], v128, s[8:11], s40 offen offset:64
    buffer_load_dwordx4 v[72:75], v128, s[8:11], s40 offen offset:128
    buffer_load_dwordx4 v[76:79], v128, s[8:11], s40 offen offset:192
    buffer_load_dwordx4 v[80:83], v128, s[8:11], s39 offen
    buffer_load_dwordx4 v[84:87], v128, s[8:11], s39 offen offset:64
    buffer_load_dwordx4 v[88:91], v128, s[8:11], s39 offen offset:128
    buffer_load_dwordx4 v[92:95], v128, s[8:11], s39 offen offset:192
    v_mov_b32 v10, 0xff800000
    v_mov_b32 v11, 0xff800000
    v_mov_b32 v130, v1
    s_mov_b32 s35, 0
L_slow_p1:
    ds_read_b128 v[32:35], v130
    ds_read_b128 v[36:39], v130 offset:512
    ds_read_b128 v[40:43], v130 offset:4096
    ds_read_b128 v[44:47], v130 offset:4608
    ds_read_b128 v[48:51], v130 offset:2048
    ds_read_b128 v[52:55], v130 offset:2560
    ds_read_b128 v[56:59], v130 offset:6144
    ds_read_b128 v[60:63], v130 offset:6656
    s_waitcnt vmcnt(7) lgkmcnt(7)
    v_mfma_f32_16x16x32_bf16 v[160:163], v[32:35], v[64:67], 0
    s_waitcnt vmcnt(6) lgkmcnt(6)
    v_mfma_f32_16x16x32_bf16 v[160:163], v[36:39], v[68:71], v[160:163]
    s_waitcnt vmcnt(5) lgkmcnt(5)
    v_mfma_f32_16x16x32_bf16 v[160:163], v[40:43], v[72:75], v[160:163]
    s_waitcnt vmcnt(4) lgkmcnt(4)
    v_mfma_f32_16x16x32_bf16 v[160:163], v[44:47], v[76:79], v[160:163]
    s_waitcnt vmcnt(3)
    v_mfma_f32_16x16x32_bf16 v[164:167], v[32:35], v[80:83], 0
    s_waitcnt vmcnt(2)
    v_mfma_f32_16x16x32_bf16 v[164:167], v[36:39], v[84:87], v[164:167]
    s_waitcnt vmcnt(1)
    v_mfma_f32_16x16x32_bf16 v[164:167], v[40:43], v[88:91], v[164:167]
    s_waitcnt vmcnt(0)
    v_mfma_f32_16x16x32_bf16 v[164:167], v[44:47], v[92:95], v[164:167]
    s_waitcnt lgkmcnt(3)
    v_mfma_f32_16x16x32_bf16 v[168:171], v[48:51], v[64:67], 0
    s_waitcnt lgkmcnt(2)
    v_mfma_f32_16x16x32_bf16 v[168:171], v[52:55], v[68:71], v[168:171]
    s_waitcnt lgkmcnt(1)
    v_mfma_f32_16x16x32_bf16 v[168:171], v[56:59], v[72:75], v[168:171]
    s_waitcnt lgkmcnt(0)
    v_mfma_f32_16x16x32_bf16 v[168:171], v[60:63], v[76:79], v[168:171]
    v_mfma_f32_16x16x32_bf16 v[172:175], v[48:51], v[80:83], 0
    v_mfma_f32_16x16x32_bf16 v[172:175], v[52:55], v[84:87], v[172:175]
    v_mfma_f32_16x16x32_bf16 v[172:175], v[56:59], v[88:91], v[172:175]
    v_mfma_f32_16x16x32_bf16 v[172:175], v[60:63], v[92:95], v[172:175]
    v_max3_f32 v10, v10, v160, v161
    v_max3_f32 v11, v11, v164, v165
    v_max3_f32 v10, v10, v162, v163
    v_max3_f32 v11, v11, v166, v167
    v_max3_f32 v10, v10, v168, v169
    s_nop 2
    v_max3_f32 v11, v11, v172, v173
    v_max3_f32 v10, v10, v170, v171
    v_max3_f32 v11, v11, v174, v175
    v_add_u32 v130, 0x2000, v130
    s_add_u32 s35, s35, 1
    s_cmp_lt_u32 s35, 8
    s_cbranch_scc1 L_slow_p1
    v_permlane32_swap_b32 v10, v11
    v_max_f32 v10, v10, v11
    v_mov_b32 v11, v10
    s_nop 1
    v_permlane16_swap_b32 v10, v11
    v_max_f32 v10, v10, v11
    v_mov_b32 v11, v10
    s_nop 1
    v_permlane32_swap_b32 v10, v11
    v_sub_f32 v16, 0, v10
    v_sub_f32 v17, 0, v10
    v_sub_f32 v18, 0, v10
    v_sub_f32 v19, 0, v10
    v_sub_f32 v20, 0, v11
    v_sub_f32 v21, 0, v11
    v_sub_f32 v22, 0, v11
    v_sub_f32 v23, 0, v11
    v_mov_b32 v24, 0
    v_mov_b32 v25, 0
    v_mov_b32 v26, 0
    v_mov_b32 v27, 0
    v_mov_b32 v130, v1
    s_mov_b32 s35, 0
    v_mov_b32 v132, v2
    v_mov_b32 v133, v3
    v_mov_b32 v134, v4
    v_mov_b32 v135, v5
    v_mov_b32 v192, 0
    v_mov_b32 v193, 0
    v_mov_b32 v194, 0
    v_mov_b32 v195, 0
    v_mov_b32 v196, 0
    v_mov_b32 v197, 0
    v_mov_b32 v198, 0
    v_mov_b32 v199, 0
    v_mov_b32 v200, 0
    v_mov_b32 v201, 0
    v_mov_b32 v202, 0
    v_mov_b32 v203, 0
    v_mov_b32 v204, 0
    v_mov_b32 v205, 0
    v_mov_b32 v206, 0
    v_mov_b32 v207, 0
    v_mov_b32 v208, 0
    v_mov_b32 v209, 0
    v_mov_b32 v210, 0
    v_mov_b32 v211, 0
    v_mov_b32 v212, 0
    v_mov_b32 v213, 0
    v_mov_b32 v214, 0
    v_mov_b32 v215, 0
    v_mov_b32 v216, 0
    v_mov_b32 v217, 0
    v_mov_b32 v218, 0
    v_mov_b32 v219, 0
    v_mov_b32 v220, 0
    v_mov_b32 v221, 0
    v_mov_b32 v222, 0
    v_mov_b32 v223, 0
    v_mov_b32 v224, 0
    v_mov_b32 v225, 0
    v_mov_b32 v226, 0
    v_mov_b32 v227, 0
    v_mov_b32 v228, 0
    v_mov_b32 v229, 0
    v_mov_b32 v230, 0
    v_mov_b32 v231, 0
    v_mov_b32 v232, 0
    v_mov_b32 v233, 0
    v_mov_b32 v234, 0
    v_mov_b32 v235, 0
    v_mov_b32 v236, 0
    v_mov_b32 v237, 0
    v_mov_b32 v238, 0
    v_mov_b32 v239, 0
    v_mov_b32 v240, 0
    v_mov_b32 v241, 0
    v_mov_b32 v242, 0
    v_mov_b32 v243, 0
    v_mov_b32 v244, 0
    v_mov_b32 v245, 0
    v_mov_b32 v246, 0
    v_mov_b32 v247, 0
    v_mov_b32 v248, 0
    v_mov_b32 v249, 0
    v_mov_b32 v250, 0
    v_mov_b32 v251, 0
    v_mov_b32 v252, 0
    v_mov_b32 v253, 0
    v_mov_b32 v254, 0
    v_mov_b32 v255, 0
L_slow_p2:
    ds_read_b128 v[32:35], v130
    ds_read_b128 v[36:39], v130 offset:512
    ds_read_b128 v[40:43], v130 offset:4096
    ds_read_b128 v[44:47], v130 offset:4608
    ds_read_b128 v[48:51], v130 offset:2048
    ds_read_b128 v[52:55], v130 offset:2560
    ds_read_b128 v[56:59], v130 offset:6144
    ds_read_b128 v[60:63], v130 offset:6656
    s_waitcnt lgkmcnt(7)
    v_mfma_f32_16x16x32_bf16 v[160:163], v[32:35], v[64:67], v[16:19]
    s_waitcnt lgkmcnt(6)
    v_mfma_f32_16x16x32_bf16 v[160:163], v[36:39], v[68:71], v[160:163]
    s_waitcnt lgkmcnt(5)
    v_mfma_f32_16x16x32_bf16 v[160:163], v[40:43], v[72:75], v[160:163]
    s_waitcnt lgkmcnt(4)
    v_mfma_f32_16x16x32_bf16 v[160:163], v[44:47], v[76:79], v[160:163]
    v_mfma_f32_16x16x32_bf16 v[164:167], v[32:35], v[80:83], v[20:23]
    v_mfma_f32_16x16x32_bf16 v[164:167], v[36:39], v[84:87], v[164:167]
    v_mfma_f32_16x16x32_bf16 v[164:167], v[40:43], v[88:91], v[164:167]
    v_mfma_f32_16x16x32_bf16 v[164:167], v[44:47], v[92:95], v[164:167]
    s_waitcnt lgkmcnt(3)
    v_mfma_f32_16x16x32_bf16 v[168:171], v[48:51], v[64:67], v[16:19]
    s_waitcnt lgkmcnt(2)
    v_mfma_f32_16x16x32_bf16 v[168:171], v[52:55], v[68:71], v[168:171]
    s_waitcnt lgkmcnt(1)
    v_mfma_f32_16x16x32_bf16 v[168:171], v[56:59], v[72:75], v[168:171]
    s_waitcnt lgkmcnt(0)
    v_mfma_f32_16x16x32_bf16 v[168:171], v[60:63], v[76:79], v[168:171]
    v_mfma_f32_16x16x32_bf16 v[172:175], v[48:51], v[80:83], v[20:23]
    v_mfma_f32_16x16x32_bf16 v[172:175], v[52:55], v[84:87], v[172:175]
    v_mfma_f32_16x16x32_bf16 v[172:175], v[56:59], v[88:91], v[172:175]
    v_mfma_f32_16x16x32_bf16 v[172:175], v[60:63], v[92:95], v[172:175]
    ds_read_b64_tr_b16 v[32:33], v132
    ds_read_b64_tr_b16 v[34:35], v132 offset:4096
    ds_read_b64_tr_b16 v[36:37], v133
    ds_read_b64_tr_b16 v[38:39], v133 offset:4096
    ds_read_b64_tr_b16 v[40:41], v134
    ds_read_b64_tr_b16 v[42:43], v134 offset:4096
    ds_read_b64_tr_b16 v[44:45], v135
    ds_read_b64_tr_b16 v[46:47], v135 offset:4096
    ds_read_b64_tr_b16 v[48:49], v132 offset:1024
    ds_read_b64_tr_b16 v[50:51], v132 offset:5120
    ds_read_b64_tr_b16 v[52:53], v133 offset:1024
    ds_read_b64_tr_b16 v[54:55], v133 offset:5120
    ds_read_b64_tr_b16 v[56:57], v134 offset:1024
    ds_read_b64_tr_b16 v[58:59], v134 offset:5120
    ds_read_b64_tr_b16 v[60:61], v135 offset:1024
    ds_read_b64_tr_b16 v[62:63], v135 offset:5120
    v_exp_f32 v160, v160
    v_exp_f32 v161, v161
    v_exp_f32 v162, v162
    v_exp_f32 v163, v163
    v_cvt_pk_bf16_f32 v160, v160, v161
    v_exp_f32 v164, v164
    v_exp_f32 v165, v165
    v_cvt_pk_bf16_f32 v161, v162, v163
    v_exp_f32 v166, v166
    v_exp_f32 v167, v167
    v_cvt_pk_bf16_f32 v164, v164, v165
    v_exp_f32 v168, v168
    v_exp_f32 v169, v169
    v_cvt_pk_bf16_f32 v165, v166, v167
    v_exp_f32 v170, v170
    v_exp_f32 v171, v171
    v_cvt_pk_bf16_f32 v162, v168, v169
    v_exp_f32 v172, v172
    v_exp_f32 v173, v173
    v_cvt_pk_bf16_f32 v163, v170, v171
    v_exp_f32 v174, v174
    v_exp_f32 v175, v175
    v_cvt_pk_bf16_f32 v166, v172, v173
    v_cvt_pk_bf16_f32 v167, v174, v175
    s_nop 1
    v_smfmac_f32_16x16x64_bf16 v[24:27], v[28:31], v[160:167], v115
    s_waitcnt lgkmcnt(14)
    v_mfma_f32_16x16x32_bf16 v[192:195], v[160:163], v[32:35], v[192:195]
    v_mfma_f32_16x16x32_bf16 v[196:199], v[164:167], v[32:35], v[196:199]
    s_waitcnt lgkmcnt(12)
    v_mfma_f32_16x16x32_bf16 v[200:203], v[160:163], v[36:39], v[200:203]
    v_mfma_f32_16x16x32_bf16 v[204:207], v[164:167], v[36:39], v[204:207]
    s_waitcnt lgkmcnt(10)
    v_mfma_f32_16x16x32_bf16 v[208:211], v[160:163], v[40:43], v[208:211]
    v_mfma_f32_16x16x32_bf16 v[212:215], v[164:167], v[40:43], v[212:215]
    s_waitcnt lgkmcnt(8)
    v_mfma_f32_16x16x32_bf16 v[216:219], v[160:163], v[44:47], v[216:219]
    v_mfma_f32_16x16x32_bf16 v[220:223], v[164:167], v[44:47], v[220:223]
    s_waitcnt lgkmcnt(6)
    v_mfma_f32_16x16x32_bf16 v[224:227], v[160:163], v[48:51], v[224:227]
    v_mfma_f32_16x16x32_bf16 v[228:231], v[164:167], v[48:51], v[228:231]
    s_waitcnt lgkmcnt(4)
    v_mfma_f32_16x16x32_bf16 v[232:235], v[160:163], v[52:55], v[232:235]
    v_mfma_f32_16x16x32_bf16 v[236:239], v[164:167], v[52:55], v[236:239]
    s_waitcnt lgkmcnt(2)
    v_mfma_f32_16x16x32_bf16 v[240:243], v[160:163], v[56:59], v[240:243]
    v_mfma_f32_16x16x32_bf16 v[244:247], v[164:167], v[56:59], v[244:247]
    s_waitcnt lgkmcnt(0)
    v_mfma_f32_16x16x32_bf16 v[248:251], v[160:163], v[60:63], v[248:251]
    v_mfma_f32_16x16x32_bf16 v[252:255], v[164:167], v[60:63], v[252:255]
    v_add_u32 v130, 0x2000, v130
    v_add_u32 v132, 0x2000, v132
    v_add_u32 v133, 0x2000, v133
    v_add_u32 v134, 0x2000, v134
    v_add_u32 v135, 0x2000, v135
    s_add_u32 s35, s35, 1
    s_cmp_lt_u32 s35, 8
    s_cbranch_scc1 L_slow_p2
    v_add_f32 v10, v24, v25
    v_add_f32 v11, v26, v27
    v_rcp_f32 v10, v10
    v_rcp_f32 v11, v11
    v_cvt_pk_bf16_f32 v0, v10, v10
    v_and_b32 v0, 0xffff0000, v0
    v_sub_f32 v0, v10, v0
    v_cvt_pk_bf16_f32 v124, v10, v0
    s_nop 1
    v_mfma_f32_16x16x32_bf16 v[116:119], v[124:127], v[12:15], 0
    v_cvt_pk_bf16_f32 v0, v11, v11
    v_and_b32 v0, 0xffff0000, v0
    v_sub_f32 v0, v11, v0
    v_cvt_pk_bf16_f32 v124, v11, v0
    s_nop 1
    v_mfma_f32_16x16x32_bf16 v[120:123], v[124:127], v[12:15], 0
    s_nop 0
    v_mul_f32 v192, v192, v116
    v_mul_f32 v200, v200, v116
    v_mul_f32 v193, v193, v117
    v_mul_f32 v201, v201, v117
    v_cvt_pk_bf16_f32 v32, v192, v200
    v_mul_f32 v194, v194, v118
    v_mul_f32 v202, v202, v118
    v_cvt_pk_bf16_f32 v36, v193, v201
    v_mul_f32 v195, v195, v119
    v_mul_f32 v203, v203, v119
    v_cvt_pk_bf16_f32 v40, v194, v202
    v_mul_f32 v196, v196, v120
    v_mul_f32 v204, v204, v120
    v_cvt_pk_bf16_f32 v44, v195, v203
    v_mul_f32 v197, v197, v121
    v_mul_f32 v205, v205, v121
    v_cvt_pk_bf16_f32 v48, v196, v204
    v_mul_f32 v198, v198, v122
    v_mul_f32 v206, v206, v122
    v_cvt_pk_bf16_f32 v52, v197, v205
    v_mul_f32 v199, v199, v123
    v_mul_f32 v207, v207, v123
    v_cvt_pk_bf16_f32 v56, v198, v206
    v_mul_f32 v208, v208, v116
    v_mul_f32 v216, v216, v116
    v_cvt_pk_bf16_f32 v60, v199, v207
    v_mul_f32 v209, v209, v117
    v_mul_f32 v217, v217, v117
    v_cvt_pk_bf16_f32 v33, v208, v216
    v_mul_f32 v210, v210, v118
    v_mul_f32 v218, v218, v118
    v_cvt_pk_bf16_f32 v37, v209, v217
    v_mul_f32 v211, v211, v119
    v_mul_f32 v219, v219, v119
    v_cvt_pk_bf16_f32 v41, v210, v218
    v_mul_f32 v212, v212, v120
    v_mul_f32 v220, v220, v120
    v_cvt_pk_bf16_f32 v45, v211, v219
    v_mul_f32 v213, v213, v121
    v_mul_f32 v221, v221, v121
    v_cvt_pk_bf16_f32 v49, v212, v220
    v_mul_f32 v214, v214, v122
    v_mul_f32 v222, v222, v122
    v_cvt_pk_bf16_f32 v53, v213, v221
    v_mul_f32 v215, v215, v123
    v_mul_f32 v223, v223, v123
    v_cvt_pk_bf16_f32 v57, v214, v222
    v_mul_f32 v224, v224, v116
    v_mul_f32 v232, v232, v116
    v_cvt_pk_bf16_f32 v61, v215, v223
    v_mul_f32 v225, v225, v117
    v_mul_f32 v233, v233, v117
    v_cvt_pk_bf16_f32 v34, v224, v232
    v_mul_f32 v226, v226, v118
    v_mul_f32 v234, v234, v118
    v_cvt_pk_bf16_f32 v38, v225, v233
    v_mul_f32 v227, v227, v119
    v_mul_f32 v235, v235, v119
    v_cvt_pk_bf16_f32 v42, v226, v234
    v_mul_f32 v228, v228, v120
    v_mul_f32 v236, v236, v120
    v_cvt_pk_bf16_f32 v46, v227, v235
    v_mul_f32 v229, v229, v121
    v_mul_f32 v237, v237, v121
    v_cvt_pk_bf16_f32 v50, v228, v236
    v_mul_f32 v230, v230, v122
    v_mul_f32 v238, v238, v122
    v_cvt_pk_bf16_f32 v54, v229, v237
    v_mul_f32 v231, v231, v123
    v_mul_f32 v239, v239, v123
    v_cvt_pk_bf16_f32 v58, v230, v238
    v_mul_f32 v240, v240, v116
    v_mul_f32 v248, v248, v116
    v_cvt_pk_bf16_f32 v62, v231, v239
    v_mul_f32 v241, v241, v117
    v_mul_f32 v249, v249, v117
    v_cvt_pk_bf16_f32 v35, v240, v248
    v_mul_f32 v242, v242, v118
    v_mul_f32 v250, v250, v118
    v_cvt_pk_bf16_f32 v39, v241, v249
    v_mul_f32 v243, v243, v119
    v_mul_f32 v251, v251, v119
    v_cvt_pk_bf16_f32 v43, v242, v250
    v_mul_f32 v244, v244, v120
    v_mul_f32 v252, v252, v120
    v_cvt_pk_bf16_f32 v47, v243, v251
    v_mul_f32 v245, v245, v121
    v_mul_f32 v253, v253, v121
    v_cvt_pk_bf16_f32 v51, v244, v252
    v_mul_f32 v246, v246, v122
    v_mul_f32 v254, v254, v122
    v_cvt_pk_bf16_f32 v55, v245, v253
    v_mul_f32 v247, v247, v123
    v_mul_f32 v255, v255, v123
    v_cvt_pk_bf16_f32 v59, v246, v254
    v_cvt_pk_bf16_f32 v63, v247, v255
    buffer_store_dwordx4 v[32:35], v7, s[20:23], s40 offen sc1
    buffer_store_dwordx4 v[36:39], v7, s[20:23], s40 offen offset:256 sc1
    buffer_store_dwordx4 v[40:43], v7, s[20:23], s40 offen offset:512 sc1
    buffer_store_dwordx4 v[44:47], v7, s[20:23], s40 offen offset:768 sc1
    buffer_store_dwordx4 v[48:51], v7, s[20:23], s39 offen sc1
    buffer_store_dwordx4 v[52:55], v7, s[20:23], s39 offen offset:256 sc1
    buffer_store_dwordx4 v[56:59], v7, s[20:23], s39 offen offset:512 sc1
    buffer_store_dwordx4 v[60:63], v7, s[20:23], s39 offen offset:768 sc1
L_slow_next:
    s_add_u32 s40, s40, 0x8000
    s_lshr_b32 s41, s41, 1
    s_cbranch_scc1 L_slow_tile
    s_endpgm
.section .rodata,"a"
.p2align 6
.amdhsa_kernel standalone__gqa_softmax__near_ridge_kernel
  .amdhsa_next_free_vgpr 256
  .amdhsa_next_free_sgpr 102
  .amdhsa_accum_offset 256
  .amdhsa_group_segment_fixed_size 0
  .amdhsa_kernarg_size 48
  .amdhsa_user_sgpr_count 2
  .amdhsa_user_sgpr_kernarg_segment_ptr 1
  .amdhsa_system_sgpr_workgroup_id_x 1
.end_amdhsa_kernel
```
